```python
import torch

def _softmax(x, axis=-1):
    return torch.softmax(x, dim=axis)
def _gelu(x):
    return torch.nn.functional.gelu(x, approximate="tanh")
def _silu(x):
    return torch.nn.functional.silu(x)
def _sigmoid(x):
    return torch.sigmoid(x)
def _layernorm(x, axis=-1, eps=1e-5):
    m = x.mean(dim=axis, keepdim=True)
    v = x.var(dim=axis, keepdim=True, unbiased=False)
    return (x - m) / torch.sqrt(v + eps)
def _scatter_add(tgt, idx, src, axis=0):
    return tgt.clone().index_add_(axis, idx, src)
def _segment_sum(src, seg, n):
    out = torch.zeros((n,) + src.shape[1:], dtype=src.dtype)
    return out.index_add_(0, seg, src)
def _pad(x, pw):
    flat = tuple(v for pair in reversed(pw) for v in pair)
    return torch.nn.functional.pad(x, flat)

kernel_name = 'standalone__paged_block_table_kv_radixattention__sampling'

def setup_inputs():

    _w = (lambda a: (lambda t: t.to(torch.bfloat16) if t.is_floating_point() else t)(torch.as_tensor(a)))
    B, H, Hkv, Dh = 32, 16, 8, 256
    Lk = 2048
    bs = 16
    nb = max(2, Lk // bs)
    P = max(1, nb // 2)
    n_phys = P + B * (nb - P)
    shared = torch.arange(P, dtype=torch.int64)
    priv = P + torch.arange(B * (nb - P), dtype=torch.int64).reshape(B, nb - P)
    bt = torch.cat([torch.tile(shared[None, :], (B, 1)), priv], dim=1)
    ctx = nb * bs - (torch.arange(1, B + 1, dtype=torch.int64) * 2654435761) % max(1, (nb * bs - P * bs) // 2)
    return {
        "q": _w((lambda *s: torch.randn(*s, dtype=torch.bfloat16) * 0.8)(B, H, Dh)),
        "k_cache": _w((lambda *s: torch.randn(*s, dtype=torch.bfloat16) * 0.8)(n_phys, bs, Hkv, Dh)),
        "v_cache": _w((lambda *s: torch.randn(*s, dtype=torch.bfloat16) * 0.05)(n_phys, bs, Hkv, Dh)),
        "block_table": _w(bt.to(torch.int64)),
        "ctx_lens": _w(torch.as_tensor(ctx).to(torch.int64)),
    }

def reference(q, k_cache, v_cache, block_table, ctx_lens):
    B, H, Dh = q.shape
    n_phys, bs, Hkv, _ = k_cache.shape
    nb = block_table.shape[1]
    Lk = nb * bs
    rep = H // Hkv
    k = k_cache[block_table].reshape(B, Lk, Hkv, Dh)
    v = v_cache[block_table].reshape(B, Lk, Hkv, Dh)
    k = (lambda x, n, axis: torch.repeat_interleave(x, n, dim=axis))(k, rep, axis=2)
    v = (lambda x, n, axis: torch.repeat_interleave(x, n, dim=axis))(v, rep, axis=2)
    scores = torch.einsum("bhd,bkhd->bhk", q, k) * (Dh ** -0.5)
    pos = torch.arange(Lk)
    valid = pos[None, :] < ctx_lens[:, None]
    scores = torch.where(valid[:, None, :], scores, -1e9)
    p = _softmax(scores, axis=-1)
    return torch.einsum("bhk,bkhd->bhd", p, v)
```

```asm
; @launch grid=(256,1,1) block=(256,1,1) lds=86016
.amdgcn_target "amdgcn-amd-amdhsa--gfx950"
.text
.globl standalone__paged_block_table_kv_radixattention__sampling_kernel
.p2align 8
.type standalone__paged_block_table_kv_radixattention__sampling_kernel,@function
standalone__paged_block_table_kv_radixattention__sampling_kernel:
    s_cmp_ge_u32 s2, 256
    s_cbranch_scc1 L_end
    s_load_dwordx16 s[4:19], s[0:1], 0
    v_lshrrev_b32 v1, 6, v0
    v_and_b32 v15, 63, v0
    v_readfirstlane_b32 s52, v1
    s_and_b32 s53, s2, 7
    s_lshr_b32 s54, s2, 3
    s_lshr_b32 s55, s54, 3
    s_lshl_b32 s76, s53, 9
    s_mov_b32 s70, 0x05040100
    s_mov_b32 s71, 0x07060302
    s_lshl_b32 s87, s52, 4
    s_lshr_b32 s88, s52, 1
    s_lshl_b32 s3, s54, 3
    s_add_u32 s3, s3, s53
    s_and_b32 s3, s3, 0xfc
    v_and_b32 v8, 15, v15
    v_lshrrev_b32 v9, 4, v15
    v_lshlrev_b32 v1, 12, v8
    v_lshl_add_u32 v1, v9, 4, v1
    v_lshlrev_b32 v2, 14, v9
    v_lshl_add_u32 v2, v8, 4, v2
    v_lshlrev_b32 v12, 2, v15
    v_and_b32 v13, 31, v15
    v_lshrrev_b32 v14, 5, v15
    v_lshlrev_b32 v13, 4, v13
    v_lshl_add_u32 v14, v14, 9, v13
    s_lshl_b32 s68, s55, 12
    s_lshl_b32 s72, s54, 9
    s_lshl_b32 s73, s52, 2
    s_add_u32 s72, s72, s73
    s_waitcnt lgkmcnt(0)
    s_mov_b32 s36, s12
    s_and_b32 s37, s13, 0xffff
    s_mov_b32 s38, 128
    s_mov_b32 s39, 0x00020000
    s_mov_b32 s32, s10
    s_and_b32 s33, s11, 0xffff
    s_mov_b32 s34, 16384
    s_mov_b32 s35, 0x00020000
    buffer_load_dword v10, v12, s[36:39], 0 offen
    buffer_load_dwordx4 v[144:147], v13, s[32:35], s68 offen
    buffer_load_dwordx4 v[128:131], v14, s[32:35], s68 offen offset:0
    buffer_load_dwordx4 v[132:135], v14, s[32:35], s68 offen offset:1024
    buffer_load_dwordx4 v[136:139], v14, s[32:35], s68 offen offset:2048
    buffer_load_dwordx4 v[140:143], v14, s[32:35], s68 offen offset:3072
    buffer_load_dword v0, v13, s[32:35], s72 offen
    s_mov_b32 s28, s4
    s_and_b32 s29, s5, 0xffff
    s_mov_b32 s30, 262144
    s_mov_b32 s31, 0x00020000
    s_mov_b32 s20, s6
    s_and_b32 s21, s7, 0xffff
    s_mov_b32 s22, 138412032
    s_mov_b32 s23, 0x00020000
    s_mov_b32 s24, s8
    s_and_b32 s25, s9, 0xffff
    s_mov_b32 s26, 138412032
    s_mov_b32 s27, 0x00020000
    s_mov_b32 s40, s14
    s_and_b32 s41, s15, 0xffff
    s_mov_b32 s42, 262144
    s_mov_b32 s43, 0x00020000
    s_mov_b32 s44, s16
    s_and_b32 s45, s17, 0xffff
    s_mov_b32 s46, 256
    s_mov_b32 s47, 0x00020000
    s_mov_b32 s48, s18
    s_and_b32 s49, s19, 0xffff
    s_mov_b32 s50, 553648128
    s_mov_b32 s51, 0x00020000
    s_waitcnt vmcnt(6)
    v_readlane_b32 s92, v10, s54
    s_bfm_b32 s93, s54, 0
    s_nop 1
    v_cmp_gt_i32 s[78:79], s92, v10
    v_cmp_eq_u32 s[80:81], s92, v10
    s_and_b32 s80, s80, s93
    s_or_b32 s78, s78, s80
    s_bcnt1_i32_b32 s68, s78
    s_lshr_b32 s56, s68, 2
    s_and_b32 s57, s68, 3
    s_and_b32 s89, s68, 8
    s_xor_b32 s89, s89, 8
    s_min_i32 s97, s92, 0x800
    s_cmp_gt_i32 s92, 0
    s_cselect_b32 s97, s97, 0x800
    s_cselect_b32 s98, 0x3db8aa3b, 0
    s_lshl_b32 s68, s57, 12
    s_lshl_b32 s73, s52, 2
    s_add_u32 s72, s68, s73
    buffer_load_dwordx4 v[176:179], v13, s[32:35], s68 offen
    buffer_load_dwordx4 v[160:163], v14, s[32:35], s68 offen offset:0
    buffer_load_dwordx4 v[164:167], v14, s[32:35], s68 offen offset:1024
    buffer_load_dwordx4 v[168:171], v14, s[32:35], s68 offen offset:2048
    buffer_load_dwordx4 v[172:175], v14, s[32:35], s68 offen offset:3072
    buffer_load_dword v3, v13, s[32:35], s72 offen
    v_lshrrev_b32 v10, 1, v8
    v_lshlrev_b32 v12, 2, v10
    s_lshl_b32 s68, s57, 5
    buffer_load_dword v4, v12, s[36:39], s68 offen
    v_lshlrev_b32 v11, 9, v8
    v_and_b32 v12, 1, v8
    v_lshlrev_b32 v11, 13, v10
    v_lshl_add_u32 v11, v12, 9, v11
    v_lshl_add_u32 v11, v9, 4, v11
    s_lshl_b32 s68, s57, 16
    s_lshl_b32 s69, s53, 10
    s_add_u32 s68, s68, s69
    buffer_load_dwordx4 v[32:35], v11, s[28:31], s68 offen offset:0
    buffer_load_dwordx4 v[36:39], v11, s[28:31], s68 offen offset:64
    buffer_load_dwordx4 v[40:43], v11, s[28:31], s68 offen offset:128
    buffer_load_dwordx4 v[44:47], v11, s[28:31], s68 offen offset:192
    buffer_load_dwordx4 v[48:51], v11, s[28:31], s68 offen offset:256
    buffer_load_dwordx4 v[52:55], v11, s[28:31], s68 offen offset:320
    buffer_load_dwordx4 v[56:59], v11, s[28:31], s68 offen offset:384
    buffer_load_dwordx4 v[60:63], v11, s[28:31], s68 offen offset:448
    s_waitcnt vmcnt(15)
    v_cmp_eq_u32 s[78:79], v128, v144
    v_cmp_eq_u32 s[80:81], v132, v144
    v_cmp_eq_u32 s[82:83], v136, v144
    v_cmp_eq_u32 s[84:85], v140, v144
    s_and_b64 s[78:79], s[78:79], s[80:81]
    s_and_b64 s[82:83], s[82:83], s[84:85]
    s_and_b64 s[78:79], s[78:79], s[82:83]
    s_and_b32 s58, s78, s79
    v_cmp_eq_u32 s[78:79], v129, v145
    v_cmp_eq_u32 s[80:81], v133, v145
    v_cmp_eq_u32 s[82:83], v137, v145
    v_cmp_eq_u32 s[84:85], v141, v145
    s_and_b64 s[78:79], s[78:79], s[80:81]
    s_and_b64 s[82:83], s[82:83], s[84:85]
    s_and_b64 s[78:79], s[78:79], s[82:83]
    s_and_b32 s59, s78, s79
    v_cmp_eq_u32 s[78:79], v130, v146
    v_cmp_eq_u32 s[80:81], v134, v146
    v_cmp_eq_u32 s[82:83], v138, v146
    v_cmp_eq_u32 s[84:85], v142, v146
    s_and_b64 s[78:79], s[78:79], s[80:81]
    s_and_b64 s[82:83], s[82:83], s[84:85]
    s_and_b64 s[78:79], s[78:79], s[82:83]
    s_and_b32 s60, s78, s79
    v_cmp_eq_u32 s[78:79], v131, v147
    v_cmp_eq_u32 s[80:81], v135, v147
    v_cmp_eq_u32 s[82:83], v139, v147
    v_cmp_eq_u32 s[84:85], v143, v147
    s_and_b64 s[78:79], s[78:79], s[80:81]
    s_and_b64 s[82:83], s[82:83], s[84:85]
    s_and_b64 s[78:79], s[78:79], s[82:83]
    s_and_b32 s61, s78, s79
    s_or_b32 s68, s58, s59
    s_or_b32 s68, s68, s60
    s_or_b32 s68, s68, s61
    s_mov_b32 s77, 0
    s_and_b32 s69, s68, 0xf
    s_cselect_b32 s69, 1, 0
    s_or_b32 s77, s77, s69
    s_and_b32 s69, s68, 0xf0
    s_cselect_b32 s69, 2, 0
    s_or_b32 s77, s77, s69
    s_and_b32 s69, s68, 0xf00
    s_cselect_b32 s69, 4, 0
    s_or_b32 s77, s77, s69
    s_and_b32 s69, s68, 0xf000
    s_cselect_b32 s69, 8, 0
    s_or_b32 s77, s77, s69
    s_and_b32 s69, s68, 0xf0000
    s_cselect_b32 s69, 16, 0
    s_or_b32 s77, s77, s69
    s_and_b32 s69, s68, 0xf00000
    s_cselect_b32 s69, 32, 0
    s_or_b32 s77, s77, s69
    s_and_b32 s69, s68, 0xf000000
    s_cselect_b32 s69, 64, 0
    s_or_b32 s77, s77, s69
    s_and_b32 s69, s68, 0xf0000000
    s_cselect_b32 s69, 128, 0
    s_or_b32 s77, s77, s69
    s_bcnt1_i32_b32 s86, s77
    s_mov_b32 s62, s58
    s_cmp_eq_u32 s52, 1
    s_cselect_b32 s62, s59, s62
    s_cmp_eq_u32 s52, 2
    s_cselect_b32 s62, s60, s62
    s_cmp_eq_u32 s52, 3
    s_cselect_b32 s62, s61, s62
    s_add_u32 s92, s97, 15
    s_lshr_b32 s92, s92, 4
    s_sub_u32 s92, s92, s52
    s_add_u32 s92, s92, 3
    s_lshr_b32 s92, s92, 2
    s_bfm_b64 s[68:69], s92, 0
    s_andn2_b32 s96, s68, s62
    v_mov_b32 v64, 0
    v_mov_b32 v65, 0
    v_mov_b32 v66, 0
    v_mov_b32 v67, 0
    v_mov_b32 v68, 0
    v_mov_b32 v69, 0
    v_mov_b32 v70, 0
    v_mov_b32 v71, 0
    v_mov_b32 v72, 0
    v_mov_b32 v73, 0
    v_mov_b32 v74, 0
    v_mov_b32 v75, 0
    v_mov_b32 v76, 0
    v_mov_b32 v77, 0
    v_mov_b32 v78, 0
    v_mov_b32 v79, 0
    v_mov_b32 v80, 0
    v_mov_b32 v81, 0
    v_mov_b32 v82, 0
    v_mov_b32 v83, 0
    v_mov_b32 v84, 0
    v_mov_b32 v85, 0
    v_mov_b32 v86, 0
    v_mov_b32 v87, 0
    v_mov_b32 v88, 0
    v_mov_b32 v89, 0
    v_mov_b32 v90, 0
    v_mov_b32 v91, 0
    v_mov_b32 v92, 0
    v_mov_b32 v93, 0
    v_mov_b32 v94, 0
    v_mov_b32 v95, 0
    v_mov_b32 v96, 0
    v_mov_b32 v97, 0
    v_mov_b32 v98, 0
    v_mov_b32 v99, 0
    v_mov_b32 v100, 0
    v_mov_b32 v101, 0
    v_mov_b32 v102, 0
    v_mov_b32 v103, 0
    v_mov_b32 v104, 0
    v_mov_b32 v105, 0
    v_mov_b32 v106, 0
    v_mov_b32 v107, 0
    v_mov_b32 v108, 0
    v_mov_b32 v109, 0
    v_mov_b32 v110, 0
    v_mov_b32 v111, 0
    v_mov_b32 v112, 0
    v_mov_b32 v113, 0
    v_mov_b32 v114, 0
    v_mov_b32 v115, 0
    v_mov_b32 v116, 0
    v_mov_b32 v117, 0
    v_mov_b32 v118, 0
    v_mov_b32 v119, 0
    v_mov_b32 v120, 0
    v_mov_b32 v121, 0
    v_mov_b32 v122, 0
    v_mov_b32 v123, 0
    v_mov_b32 v124, 0
    v_mov_b32 v125, 0
    v_mov_b32 v126, 0
    v_mov_b32 v127, 0
    v_mov_b32 v5, 0xf149f2ca
    v_mov_b32 v6, 0
    s_mov_b32 s90, 0
    s_waitcnt vmcnt(8)
    v_cmp_eq_u32 s[78:79], v160, v176
    v_cmp_eq_u32 s[80:81], v164, v176
    v_cmp_eq_u32 s[82:83], v168, v176
    v_cmp_eq_u32 s[84:85], v172, v176
    s_and_b64 s[78:79], s[78:79], s[80:81]
    s_and_b64 s[82:83], s[82:83], s[84:85]
    s_and_b64 s[78:79], s[78:79], s[82:83]
    s_and_b32 s58, s78, s79
    v_cmp_eq_u32 s[78:79], v161, v177
    v_cmp_eq_u32 s[80:81], v165, v177
    v_cmp_eq_u32 s[82:83], v169, v177
    v_cmp_eq_u32 s[84:85], v173, v177
    s_and_b64 s[78:79], s[78:79], s[80:81]
    s_and_b64 s[82:83], s[82:83], s[84:85]
    s_and_b64 s[78:79], s[78:79], s[82:83]
    s_and_b32 s59, s78, s79
    v_cmp_eq_u32 s[78:79], v162, v178
    v_cmp_eq_u32 s[80:81], v166, v178
    v_cmp_eq_u32 s[82:83], v170, v178
    v_cmp_eq_u32 s[84:85], v174, v178
    s_and_b64 s[78:79], s[78:79], s[80:81]
    s_and_b64 s[82:83], s[82:83], s[84:85]
    s_and_b64 s[78:79], s[78:79], s[82:83]
    s_and_b32 s60, s78, s79
    v_cmp_eq_u32 s[78:79], v163, v179
    v_cmp_eq_u32 s[80:81], v167, v179
    v_cmp_eq_u32 s[82:83], v171, v179
    v_cmp_eq_u32 s[84:85], v175, v179
    s_and_b64 s[78:79], s[78:79], s[80:81]
    s_and_b64 s[82:83], s[82:83], s[84:85]
    s_and_b64 s[78:79], s[78:79], s[82:83]
    s_and_b32 s61, s78, s79
    s_or_b32 s68, s58, s59
    s_or_b32 s68, s68, s60
    s_or_b32 s68, s68, s61
    s_mov_b32 s99, 0
    s_and_b32 s69, s68, 0xf
    s_cselect_b32 s69, 1, 0
    s_or_b32 s99, s99, s69
    s_and_b32 s69, s68, 0xf0
    s_cselect_b32 s69, 2, 0
    s_or_b32 s99, s99, s69
    s_and_b32 s69, s68, 0xf00
    s_cselect_b32 s69, 4, 0
    s_or_b32 s99, s99, s69
    s_and_b32 s69, s68, 0xf000
    s_cselect_b32 s69, 8, 0
    s_or_b32 s99, s99, s69
    s_and_b32 s69, s68, 0xf0000
    s_cselect_b32 s69, 16, 0
    s_or_b32 s99, s99, s69
    s_and_b32 s69, s68, 0xf00000
    s_cselect_b32 s69, 32, 0
    s_or_b32 s99, s99, s69
    s_and_b32 s69, s68, 0xf000000
    s_cselect_b32 s69, 64, 0
    s_or_b32 s99, s99, s69
    s_and_b32 s69, s68, 0xf0000000
    s_cselect_b32 s69, 128, 0
    s_or_b32 s99, s99, s69
    s_bcnt1_i32_b32 s100, s99
    s_mov_b32 s62, s58
    s_cmp_eq_u32 s52, 1
    s_cselect_b32 s62, s59, s62
    s_cmp_eq_u32 s52, 2
    s_cselect_b32 s62, s60, s62
    s_cmp_eq_u32 s52, 3
    s_cselect_b32 s62, s61, s62
    s_lshr_b32 s68, s99, s56
    s_and_b32 s68, s68, 1
    s_cbranch_scc0 L_noA
    s_lshl_b32 s68, s56, 2
    s_lshl_b32 s68, 0xf, s68
    s_and_b32 s62, s62, s68
    s_bcnt1_i32_b32 s63, s62
    v_cmp_lt_i32 vcc, 0, v4
    v_min_i32 v12, 0x800, v4
    v_mov_b32 v13, 0x800
    v_cndmask_b32 v12, v13, v12, vcc
    v_mov_b32 v13, 0x3db8aa3b
    v_cndmask_b32 v7, 0, v13, vcc
    v_lshlrev_b32 v9, 2, v9
    v_sub_u32 v4, v12, v9
    s_cmp_eq_u32 s63, 0
    s_cbranch_scc1 L_A_loopdone
    s_cmp_eq_u32 s62, 0
    s_cbranch_scc1 L_none_1
    s_ff1_i32_b32 s68, s62
    s_bitset0_b32 s62, s68
    v_readlane_b32 s69, v3, s68
    s_lshl_b32 s66, s68, 6
    s_add_u32 s66, s66, s87
    s_nop 1
    s_lshl_b32 s69, s69, 16
    s_add_u32 s64, s69, s76
    s_branch L_go_2
L_none_1:
    s_mov_b32 s64, 138412032
L_go_2:
    buffer_load_dwordx4 v[128:131], v1, s[20:23], s64 offen offset:0
    buffer_load_dwordx4 v[132:135], v1, s[20:23], s64 offen offset:64
    buffer_load_dwordx4 v[136:139], v1, s[20:23], s64 offen offset:128
    buffer_load_dwordx4 v[140:143], v1, s[20:23], s64 offen offset:192
    buffer_load_dwordx4 v[144:147], v1, s[20:23], s64 offen offset:256
    buffer_load_dwordx4 v[148:151], v1, s[20:23], s64 offen offset:320
    buffer_load_dwordx4 v[152:155], v1, s[20:23], s64 offen offset:384
    buffer_load_dwordx4 v[156:159], v1, s[20:23], s64 offen offset:448
    s_add_u32 s73, s64, 0x1000
    s_add_u32 s74, s64, 0x2000
    s_add_u32 s75, s64, 0x3000
    buffer_load_dwordx4 v[160:163], v2, s[24:27], s64 offen offset:0
    buffer_load_dwordx4 v[164:167], v2, s[24:27], s64 offen offset:256
    buffer_load_dwordx4 v[168:171], v2, s[24:27], s73 offen offset:0
    buffer_load_dwordx4 v[172:175], v2, s[24:27], s73 offen offset:256
    buffer_load_dwordx4 v[176:179], v2, s[24:27], s74 offen offset:0
    buffer_load_dwordx4 v[180:183], v2, s[24:27], s74 offen offset:256
    buffer_load_dwordx4 v[184:187], v2, s[24:27], s75 offen offset:0
    buffer_load_dwordx4 v[188:191], v2, s[24:27], s75 offen offset:256
    s_cmp_eq_u32 s62, 0
    s_cbranch_scc1 L_none_3
    s_ff1_i32_b32 s68, s62
    s_bitset0_b32 s62, s68
    v_readlane_b32 s69, v3, s68
    s_lshl_b32 s67, s68, 6
    s_add_u32 s67, s67, s87
    s_nop 1
    s_lshl_b32 s69, s69, 16
    s_add_u32 s65, s69, s76
    s_branch L_go_4
L_none_3:
    s_mov_b32 s65, 138412032
L_go_4:
    buffer_load_dwordx4 v[192:195], v1, s[20:23], s65 offen offset:0
    buffer_load_dwordx4 v[196:199], v1, s[20:23], s65 offen offset:64
    buffer_load_dwordx4 v[200:203], v1, s[20:23], s65 offen offset:128
    buffer_load_dwordx4 v[204:207], v1, s[20:23], s65 offen offset:192
    buffer_load_dwordx4 v[208:211], v1, s[20:23], s65 offen offset:256
    buffer_load_dwordx4 v[212:215], v1, s[20:23], s65 offen offset:320
    buffer_load_dwordx4 v[216:219], v1, s[20:23], s65 offen offset:384
    buffer_load_dwordx4 v[220:223], v1, s[20:23], s65 offen offset:448
    s_add_u32 s73, s65, 0x1000
    s_add_u32 s74, s65, 0x2000
    s_add_u32 s75, s65, 0x3000
    buffer_load_dwordx4 v[224:227], v2, s[24:27], s65 offen offset:0
    buffer_load_dwordx4 v[228:231], v2, s[24:27], s65 offen offset:256
    buffer_load_dwordx4 v[232:235], v2, s[24:27], s73 offen offset:0
    buffer_load_dwordx4 v[236:239], v2, s[24:27], s73 offen offset:256
    buffer_load_dwordx4 v[240:243], v2, s[24:27], s74 offen offset:0
    buffer_load_dwordx4 v[244:247], v2, s[24:27], s74 offen offset:256
    buffer_load_dwordx4 v[248:251], v2, s[24:27], s75 offen offset:0
    buffer_load_dwordx4 v[252:255], v2, s[24:27], s75 offen offset:256
L_loop_5:
    s_waitcnt vmcnt(24)
    v_mfma_f32_16x16x32_bf16 v[8:11], v[128:131], v[32:35], 0
    v_mfma_f32_16x16x32_bf16 v[8:11], v[132:135], v[36:39], v[8:11]
    v_mfma_f32_16x16x32_bf16 v[8:11], v[136:139], v[40:43], v[8:11]
    v_mfma_f32_16x16x32_bf16 v[8:11], v[140:143], v[44:47], v[8:11]
    v_mfma_f32_16x16x32_bf16 v[8:11], v[144:147], v[48:51], v[8:11]
    v_mfma_f32_16x16x32_bf16 v[8:11], v[148:151], v[52:55], v[8:11]
    v_mfma_f32_16x16x32_bf16 v[8:11], v[152:155], v[56:59], v[8:11]
    v_mfma_f32_16x16x32_bf16 v[8:11], v[156:159], v[60:63], v[8:11]
    v_subrev_u32 v12, s66, v4
    s_cmp_eq_u32 s62, 0
    s_cbranch_scc1 L_none_7
    s_ff1_i32_b32 s68, s62
    s_bitset0_b32 s62, s68
    v_readlane_b32 s69, v3, s68
    s_lshl_b32 s66, s68, 6
    s_add_u32 s66, s66, s87
    s_nop 1
    s_lshl_b32 s69, s69, 16
    s_add_u32 s64, s69, s76
    s_branch L_go_8
L_none_7:
    s_mov_b32 s64, 138412032
L_go_8:
    buffer_load_dwordx4 v[128:131], v1, s[20:23], s64 offen offset:0
    buffer_load_dwordx4 v[132:135], v1, s[20:23], s64 offen offset:64
    buffer_load_dwordx4 v[136:139], v1, s[20:23], s64 offen offset:128
    buffer_load_dwordx4 v[140:143], v1, s[20:23], s64 offen offset:192
    buffer_load_dwordx4 v[144:147], v1, s[20:23], s64 offen offset:256
    buffer_load_dwordx4 v[148:151], v1, s[20:23], s64 offen offset:320
    buffer_load_dwordx4 v[152:155], v1, s[20:23], s64 offen offset:384
    buffer_load_dwordx4 v[156:159], v1, s[20:23], s64 offen offset:448
    v_mov_b32 v13, 0xff61b1e6
    v_cmp_lt_i32 vcc, 0, v12
    v_mul_f32 v8, v7, v8
    v_mul_f32 v9, v7, v9
    v_cndmask_b32 v8, v13, v8, vcc
    v_cmp_lt_i32 vcc, 1, v12
    v_mul_f32 v10, v7, v10
    v_mul_f32 v11, v7, v11
    v_cndmask_b32 v9, v13, v9, vcc
    v_cmp_lt_i32 vcc, 2, v12
    s_nop 1
    v_cndmask_b32 v10, v13, v10, vcc
    v_cmp_lt_i32 vcc, 3, v12
    s_nop 1
    v_cndmask_b32 v11, v13, v11, vcc
    v_max3_f32 v12, v8, v9, v10
    v_max_f32 v12, v12, v11
    v_mov_b32 v13, v12
    s_nop 1
    v_permlane16_swap_b32 v12, v13
    v_max_f32 v12, v12, v13
    v_mov_b32 v13, v12
    s_nop 1
    v_permlane32_swap_b32 v12, v13
    v_max3_f32 v12, v12, v13, v5
    v_sub_f32 v13, v5, v12
    v_exp_f32 v13, v13
    v_mov_b32 v5, v12
    v_sub_f32 v8, v8, v12
    v_sub_f32 v9, v9, v12
    v_sub_f32 v10, v10, v12
    v_sub_f32 v11, v11, v12
    v_exp_f32 v8, v8
    v_exp_f32 v9, v9
    v_exp_f32 v10, v10
    v_exp_f32 v11, v11
    v_cmp_neq_f32 vcc, 1.0, v13
    v_add_f32 v12, v8, v9
    v_add_f32 v12, v12, v10
    v_add_f32 v12, v12, v11
    v_fma_f32 v6, v6, v13, v12
    v_cvt_pk_bf16_f32 v14, v8, v9
    v_cvt_pk_bf16_f32 v15, v10, v11
    s_cbranch_vccz L_nors_9
    v_mul_f32 v64, v13, v64
    v_mul_f32 v65, v13, v65
    v_mul_f32 v66, v13, v66
    v_mul_f32 v67, v13, v67
    v_mul_f32 v68, v13, v68
    v_mul_f32 v69, v13, v69
    v_mul_f32 v70, v13, v70
    v_mul_f32 v71, v13, v71
    v_mul_f32 v72, v13, v72
    v_mul_f32 v73, v13, v73
    v_mul_f32 v74, v13, v74
    v_mul_f32 v75, v13, v75
    v_mul_f32 v76, v13, v76
    v_mul_f32 v77, v13, v77
    v_mul_f32 v78, v13, v78
    v_mul_f32 v79, v13, v79
    v_mul_f32 v80, v13, v80
    v_mul_f32 v81, v13, v81
    v_mul_f32 v82, v13, v82
    v_mul_f32 v83, v13, v83
    v_mul_f32 v84, v13, v84
    v_mul_f32 v85, v13, v85
    v_mul_f32 v86, v13, v86
    v_mul_f32 v87, v13, v87
    v_mul_f32 v88, v13, v88
    v_mul_f32 v89, v13, v89
    v_mul_f32 v90, v13, v90
    v_mul_f32 v91, v13, v91
    v_mul_f32 v92, v13, v92
    v_mul_f32 v93, v13, v93
    v_mul_f32 v94, v13, v94
    v_mul_f32 v95, v13, v95
    v_mul_f32 v96, v13, v96
    v_mul_f32 v97, v13, v97
    v_mul_f32 v98, v13, v98
    v_mul_f32 v99, v13, v99
    v_mul_f32 v100, v13, v100
    v_mul_f32 v101, v13, v101
    v_mul_f32 v102, v13, v102
    v_mul_f32 v103, v13, v103
    v_mul_f32 v104, v13, v104
    v_mul_f32 v105, v13, v105
    v_mul_f32 v106, v13, v106
    v_mul_f32 v107, v13, v107
    v_mul_f32 v108, v13, v108
    v_mul_f32 v109, v13, v109
    v_mul_f32 v110, v13, v110
    v_mul_f32 v111, v13, v111
    v_mul_f32 v112, v13, v112
    v_mul_f32 v113, v13, v113
    v_mul_f32 v114, v13, v114
    v_mul_f32 v115, v13, v115
    v_mul_f32 v116, v13, v116
    v_mul_f32 v117, v13, v117
    v_mul_f32 v118, v13, v118
    v_mul_f32 v119, v13, v119
    v_mul_f32 v120, v13, v120
    v_mul_f32 v121, v13, v121
    v_mul_f32 v122, v13, v122
    v_mul_f32 v123, v13, v123
    v_mul_f32 v124, v13, v124
    v_mul_f32 v125, v13, v125
    v_mul_f32 v126, v13, v126
    v_mul_f32 v127, v13, v127
L_nors_9:
    s_waitcnt vmcnt(24)
    v_perm_b32 v16, v168, v160, s70
    v_perm_b32 v17, v184, v176, s70
    v_perm_b32 v18, v168, v160, s71
    v_perm_b32 v19, v184, v176, s71
    v_perm_b32 v20, v169, v161, s70
    v_perm_b32 v21, v185, v177, s70
    v_perm_b32 v22, v169, v161, s71
    v_perm_b32 v23, v185, v177, s71
    v_mfma_f32_16x16x16_bf16 v[64:67], v[16:17], v[14:15], v[64:67]
    v_mfma_f32_16x16x16_bf16 v[68:71], v[18:19], v[14:15], v[68:71]
    v_perm_b32 v24, v170, v162, s70
    v_perm_b32 v25, v186, v178, s70
    v_perm_b32 v26, v170, v162, s71
    v_perm_b32 v27, v186, v178, s71
    v_mfma_f32_16x16x16_bf16 v[72:75], v[20:21], v[14:15], v[72:75]
    v_mfma_f32_16x16x16_bf16 v[76:79], v[22:23], v[14:15], v[76:79]
    v_perm_b32 v28, v171, v163, s70
    v_perm_b32 v29, v187, v179, s70
    v_perm_b32 v30, v171, v163, s71
    v_perm_b32 v31, v187, v179, s71
    v_mfma_f32_16x16x16_bf16 v[80:83], v[24:25], v[14:15], v[80:83]
    v_mfma_f32_16x16x16_bf16 v[84:87], v[26:27], v[14:15], v[84:87]
    v_perm_b32 v16, v172, v164, s70
    v_perm_b32 v17, v188, v180, s70
    v_perm_b32 v18, v172, v164, s71
    v_perm_b32 v19, v188, v180, s71
    v_mfma_f32_16x16x16_bf16 v[88:91], v[28:29], v[14:15], v[88:91]
    v_mfma_f32_16x16x16_bf16 v[92:95], v[30:31], v[14:15], v[92:95]
    v_perm_b32 v20, v173, v165, s70
    v_perm_b32 v21, v189, v181, s70
    v_perm_b32 v22, v173, v165, s71
    v_perm_b32 v23, v189, v181, s71
    v_mfma_f32_16x16x16_bf16 v[96:99], v[16:17], v[14:15], v[96:99]
    v_mfma_f32_16x16x16_bf16 v[100:103], v[18:19], v[14:15], v[100:103]
    v_perm_b32 v24, v174, v166, s70
    v_perm_b32 v25, v190, v182, s70
    v_perm_b32 v26, v174, v166, s71
    v_perm_b32 v27, v190, v182, s71
    v_mfma_f32_16x16x16_bf16 v[104:107], v[20:21], v[14:15], v[104:107]
    v_mfma_f32_16x16x16_bf16 v[108:111], v[22:23], v[14:15], v[108:111]
    v_perm_b32 v28, v175, v167, s70
    v_perm_b32 v29, v191, v183, s70
    v_perm_b32 v30, v175, v167, s71
    v_perm_b32 v31, v191, v183, s71
    v_mfma_f32_16x16x16_bf16 v[112:115], v[24:25], v[14:15], v[112:115]
    v_mfma_f32_16x16x16_bf16 v[116:119], v[26:27], v[14:15], v[116:119]
    s_add_u32 s73, s64, 0x1000
    s_add_u32 s74, s64, 0x2000
    s_add_u32 s75, s64, 0x3000
    buffer_load_dwordx4 v[160:163], v2, s[24:27], s64 offen offset:0
    buffer_load_dwordx4 v[164:167], v2, s[24:27], s64 offen offset:256
    buffer_load_dwordx4 v[168:171], v2, s[24:27], s73 offen offset:0
    buffer_load_dwordx4 v[172:175], v2, s[24:27], s73 offen offset:256
    buffer_load_dwordx4 v[176:179], v2, s[24:27], s74 offen offset:0
    buffer_load_dwordx4 v[180:183], v2, s[24:27], s74 offen offset:256
    buffer_load_dwordx4 v[184:187], v2, s[24:27], s75 offen offset:0
    buffer_load_dwordx4 v[188:191], v2, s[24:27], s75 offen offset:256
    v_mfma_f32_16x16x16_bf16 v[120:123], v[28:29], v[14:15], v[120:123]
    v_mfma_f32_16x16x16_bf16 v[124:127], v[30:31], v[14:15], v[124:127]
    s_sub_u32 s63, s63, 1
    s_cmp_eq_u32 s63, 0
    s_cbranch_scc1 L_ldone_6
    s_waitcnt vmcnt(24)
    v_mfma_f32_16x16x32_bf16 v[8:11], v[192:195], v[32:35], 0
    v_mfma_f32_16x16x32_bf16 v[8:11], v[196:199], v[36:39], v[8:11]
    v_mfma_f32_16x16x32_bf16 v[8:11], v[200:203], v[40:43], v[8:11]
    v_mfma_f32_16x16x32_bf16 v[8:11], v[204:207], v[44:47], v[8:11]
    v_mfma_f32_16x16x32_bf16 v[8:11], v[208:211], v[48:51], v[8:11]
    v_mfma_f32_16x16x32_bf16 v[8:11], v[212:215], v[52:55], v[8:11]
    v_mfma_f32_16x16x32_bf16 v[8:11], v[216:219], v[56:59], v[8:11]
    v_mfma_f32_16x16x32_bf16 v[8:11], v[220:223], v[60:63], v[8:11]
    v_subrev_u32 v12, s67, v4
    s_cmp_eq_u32 s62, 0
    s_cbranch_scc1 L_none_10
    s_ff1_i32_b32 s68, s62
    s_bitset0_b32 s62, s68
    v_readlane_b32 s69, v3, s68
    s_lshl_b32 s67, s68, 6
    s_add_u32 s67, s67, s87
    s_nop 1
    s_lshl_b32 s69, s69, 16
    s_add_u32 s65, s69, s76
    s_branch L_go_11
L_none_10:
    s_mov_b32 s65, 138412032
L_go_11:
    buffer_load_dwordx4 v[192:195], v1, s[20:23], s65 offen offset:0
    buffer_load_dwordx4 v[196:199], v1, s[20:23], s65 offen offset:64
    buffer_load_dwordx4 v[200:203], v1, s[20:23], s65 offen offset:128
    buffer_load_dwordx4 v[204:207], v1, s[20:23], s65 offen offset:192
    buffer_load_dwordx4 v[208:211], v1, s[20:23], s65 offen offset:256
    buffer_load_dwordx4 v[212:215], v1, s[20:23], s65 offen offset:320
    buffer_load_dwordx4 v[216:219], v1, s[20:23], s65 offen offset:384
    buffer_load_dwordx4 v[220:223], v1, s[20:23], s65 offen offset:448
    v_mov_b32 v13, 0xff61b1e6
    v_cmp_lt_i32 vcc, 0, v12
    v_mul_f32 v8, v7, v8
    v_mul_f32 v9, v7, v9
    v_cndmask_b32 v8, v13, v8, vcc
    v_cmp_lt_i32 vcc, 1, v12
    v_mul_f32 v10, v7, v10
    v_mul_f32 v11, v7, v11
    v_cndmask_b32 v9, v13, v9, vcc
    v_cmp_lt_i32 vcc, 2, v12
    s_nop 1
    v_cndmask_b32 v10, v13, v10, vcc
    v_cmp_lt_i32 vcc, 3, v12
    s_nop 1
    v_cndmask_b32 v11, v13, v11, vcc
    v_max3_f32 v12, v8, v9, v10
    v_max_f32 v12, v12, v11
    v_mov_b32 v13, v12
    s_nop 1
    v_permlane16_swap_b32 v12, v13
    v_max_f32 v12, v12, v13
    v_mov_b32 v13, v12
    s_nop 1
    v_permlane32_swap_b32 v12, v13
    v_max3_f32 v12, v12, v13, v5
    v_sub_f32 v13, v5, v12
    v_exp_f32 v13, v13
    v_mov_b32 v5, v12
    v_sub_f32 v8, v8, v12
    v_sub_f32 v9, v9, v12
    v_sub_f32 v10, v10, v12
    v_sub_f32 v11, v11, v12
    v_exp_f32 v8, v8
    v_exp_f32 v9, v9
    v_exp_f32 v10, v10
    v_exp_f32 v11, v11
    v_cmp_neq_f32 vcc, 1.0, v13
    v_add_f32 v12, v8, v9
    v_add_f32 v12, v12, v10
    v_add_f32 v12, v12, v11
    v_fma_f32 v6, v6, v13, v12
    v_cvt_pk_bf16_f32 v14, v8, v9
    v_cvt_pk_bf16_f32 v15, v10, v11
    s_cbranch_vccz L_nors_12
    v_mul_f32 v64, v13, v64
    v_mul_f32 v65, v13, v65
    v_mul_f32 v66, v13, v66
    v_mul_f32 v67, v13, v67
    v_mul_f32 v68, v13, v68
    v_mul_f32 v69, v13, v69
    v_mul_f32 v70, v13, v70
    v_mul_f32 v71, v13, v71
    v_mul_f32 v72, v13, v72
    v_mul_f32 v73, v13, v73
    v_mul_f32 v74, v13, v74
    v_mul_f32 v75, v13, v75
    v_mul_f32 v76, v13, v76
    v_mul_f32 v77, v13, v77
    v_mul_f32 v78, v13, v78
    v_mul_f32 v79, v13, v79
    v_mul_f32 v80, v13, v80
    v_mul_f32 v81, v13, v81
    v_mul_f32 v82, v13, v82
    v_mul_f32 v83, v13, v83
    v_mul_f32 v84, v13, v84
    v_mul_f32 v85, v13, v85
    v_mul_f32 v86, v13, v86
    v_mul_f32 v87, v13, v87
    v_mul_f32 v88, v13, v88
    v_mul_f32 v89, v13, v89
    v_mul_f32 v90, v13, v90
    v_mul_f32 v91, v13, v91
    v_mul_f32 v92, v13, v92
    v_mul_f32 v93, v13, v93
    v_mul_f32 v94, v13, v94
    v_mul_f32 v95, v13, v95
    v_mul_f32 v96, v13, v96
    v_mul_f32 v97, v13, v97
    v_mul_f32 v98, v13, v98
    v_mul_f32 v99, v13, v99
    v_mul_f32 v100, v13, v100
    v_mul_f32 v101, v13, v101
    v_mul_f32 v102, v13, v102
    v_mul_f32 v103, v13, v103
    v_mul_f32 v104, v13, v104
    v_mul_f32 v105, v13, v105
    v_mul_f32 v106, v13, v106
    v_mul_f32 v107, v13, v107
    v_mul_f32 v108, v13, v108
    v_mul_f32 v109, v13, v109
    v_mul_f32 v110, v13, v110
    v_mul_f32 v111, v13, v111
    v_mul_f32 v112, v13, v112
    v_mul_f32 v113, v13, v113
    v_mul_f32 v114, v13, v114
    v_mul_f32 v115, v13, v115
    v_mul_f32 v116, v13, v116
    v_mul_f32 v117, v13, v117
    v_mul_f32 v118, v13, v118
    v_mul_f32 v119, v13, v119
    v_mul_f32 v120, v13, v120
    v_mul_f32 v121, v13, v121
    v_mul_f32 v122, v13, v122
    v_mul_f32 v123, v13, v123
    v_mul_f32 v124, v13, v124
    v_mul_f32 v125, v13, v125
    v_mul_f32 v126, v13, v126
    v_mul_f32 v127, v13, v127
L_nors_12:
    s_waitcnt vmcnt(24)
    v_perm_b32 v16, v232, v224, s70
    v_perm_b32 v17, v248, v240, s70
    v_perm_b32 v18, v232, v224, s71
    v_perm_b32 v19, v248, v240, s71
    v_perm_b32 v20, v233, v225, s70
    v_perm_b32 v21, v249, v241, s70
    v_perm_b32 v22, v233, v225, s71
    v_perm_b32 v23, v249, v241, s71
    v_mfma_f32_16x16x16_bf16 v[64:67], v[16:17], v[14:15], v[64:67]
    v_mfma_f32_16x16x16_bf16 v[68:71], v[18:19], v[14:15], v[68:71]
    v_perm_b32 v24, v234, v226, s70
    v_perm_b32 v25, v250, v242, s70
    v_perm_b32 v26, v234, v226, s71
    v_perm_b32 v27, v250, v242, s71
    v_mfma_f32_16x16x16_bf16 v[72:75], v[20:21], v[14:15], v[72:75]
    v_mfma_f32_16x16x16_bf16 v[76:79], v[22:23], v[14:15], v[76:79]
    v_perm_b32 v28, v235, v227, s70
    v_perm_b32 v29, v251, v243, s70
    v_perm_b32 v30, v235, v227, s71
    v_perm_b32 v31, v251, v243, s71
    v_mfma_f32_16x16x16_bf16 v[80:83], v[24:25], v[14:15], v[80:83]
    v_mfma_f32_16x16x16_bf16 v[84:87], v[26:27], v[14:15], v[84:87]
    v_perm_b32 v16, v236, v228, s70
    v_perm_b32 v17, v252, v244, s70
    v_perm_b32 v18, v236, v228, s71
    v_perm_b32 v19, v252, v244, s71
    v_mfma_f32_16x16x16_bf16 v[88:91], v[28:29], v[14:15], v[88:91]
    v_mfma_f32_16x16x16_bf16 v[92:95], v[30:31], v[14:15], v[92:95]
    v_perm_b32 v20, v237, v229, s70
    v_perm_b32 v21, v253, v245, s70
    v_perm_b32 v22, v237, v229, s71
    v_perm_b32 v23, v253, v245, s71
    v_mfma_f32_16x16x16_bf16 v[96:99], v[16:17], v[14:15], v[96:99]
    v_mfma_f32_16x16x16_bf16 v[100:103], v[18:19], v[14:15], v[100:103]
    v_perm_b32 v24, v238, v230, s70
    v_perm_b32 v25, v254, v246, s70
    v_perm_b32 v26, v238, v230, s71
    v_perm_b32 v27, v254, v246, s71
    v_mfma_f32_16x16x16_bf16 v[104:107], v[20:21], v[14:15], v[104:107]
    v_mfma_f32_16x16x16_bf16 v[108:111], v[22:23], v[14:15], v[108:111]
    v_perm_b32 v28, v239, v231, s70
    v_perm_b32 v29, v255, v247, s70
    v_perm_b32 v30, v239, v231, s71
    v_perm_b32 v31, v255, v247, s71
    v_mfma_f32_16x16x16_bf16 v[112:115], v[24:25], v[14:15], v[112:115]
    v_mfma_f32_16x16x16_bf16 v[116:119], v[26:27], v[14:15], v[116:119]
    s_add_u32 s73, s65, 0x1000
    s_add_u32 s74, s65, 0x2000
    s_add_u32 s75, s65, 0x3000
    buffer_load_dwordx4 v[224:227], v2, s[24:27], s65 offen offset:0
    buffer_load_dwordx4 v[228:231], v2, s[24:27], s65 offen offset:256
    buffer_load_dwordx4 v[232:235], v2, s[24:27], s73 offen offset:0
    buffer_load_dwordx4 v[236:239], v2, s[24:27], s73 offen offset:256
    buffer_load_dwordx4 v[240:243], v2, s[24:27], s74 offen offset:0
    buffer_load_dwordx4 v[244:247], v2, s[24:27], s74 offen offset:256
    buffer_load_dwordx4 v[248:251], v2, s[24:27], s75 offen offset:0
    buffer_load_dwordx4 v[252:255], v2, s[24:27], s75 offen offset:256
    v_mfma_f32_16x16x16_bf16 v[120:123], v[28:29], v[14:15], v[120:123]
    v_mfma_f32_16x16x16_bf16 v[124:127], v[30:31], v[14:15], v[124:127]
    s_sub_u32 s63, s63, 1
    s_cmp_lg_u32 s63, 0
    s_cbranch_scc1 L_loop_5
L_ldone_6:
L_A_loopdone:
    s_waitcnt vmcnt(0)
    v_mbcnt_lo_u32_b32 v16, -1, 0
    v_mbcnt_hi_u32_b32 v16, -1, v16
    v_and_b32 v17, 1, v16
    v_lshrrev_b32 v18, 4, v16
    v_lshlrev_b32 v17, 9, v17
    v_lshl_add_u32 v17, v18, 4, v17
    s_lshl_b32 s68, s54, 13
    s_lshl_b32 s69, s53, 10
    s_add_u32 s68, s68, s69
    buffer_load_dwordx4 v[32:35], v17, s[28:31], s68 offen offset:0
    buffer_load_dwordx4 v[36:39], v17, s[28:31], s68 offen offset:64
    buffer_load_dwordx4 v[40:43], v17, s[28:31], s68 offen offset:128
    buffer_load_dwordx4 v[44:47], v17, s[28:31], s68 offen offset:192
    buffer_load_dwordx4 v[48:51], v17, s[28:31], s68 offen offset:256
    buffer_load_dwordx4 v[52:55], v17, s[28:31], s68 offen offset:320
    buffer_load_dwordx4 v[56:59], v17, s[28:31], s68 offen offset:384
    buffer_load_dwordx4 v[60:63], v17, s[28:31], s68 offen offset:448
    v_lshlrev_b32 v18, 2, v18
    v_sub_u32 v4, s97, v18
    s_mov_b32 s62, s96
    s_cmp_eq_u32 s62, 0
    s_cbranch_scc1 L_none_13
    s_ff1_i32_b32 s68, s62
    s_bitset0_b32 s62, s68
    v_readlane_b32 s69, v0, s68
    s_lshl_b32 s66, s68, 6
    s_add_u32 s66, s66, s87
    s_nop 1
    s_lshl_b32 s69, s69, 16
    s_add_u32 s64, s69, s76
    s_branch L_go_14
L_none_13:
    s_mov_b32 s64, 138412032
L_go_14:
    buffer_load_dwordx4 v[128:131], v1, s[20:23], s64 offen offset:0 nt
    buffer_load_dwordx4 v[132:135], v1, s[20:23], s64 offen offset:64 nt
    buffer_load_dwordx4 v[136:139], v1, s[20:23], s64 offen offset:128 nt
    buffer_load_dwordx4 v[140:143], v1, s[20:23], s64 offen offset:192 nt
    buffer_load_dwordx4 v[144:147], v1, s[20:23], s64 offen offset:256 nt
    buffer_load_dwordx4 v[148:151], v1, s[20:23], s64 offen offset:320 nt
    buffer_load_dwordx4 v[152:155], v1, s[20:23], s64 offen offset:384 nt
    buffer_load_dwordx4 v[156:159], v1, s[20:23], s64 offen offset:448 nt
    s_add_u32 s73, s64, 0x1000
    s_add_u32 s74, s64, 0x2000
    s_add_u32 s75, s64, 0x3000
    buffer_load_dwordx4 v[160:163], v2, s[24:27], s64 offen offset:0 nt
    buffer_load_dwordx4 v[164:167], v2, s[24:27], s64 offen offset:256 nt
    buffer_load_dwordx4 v[168:171], v2, s[24:27], s73 offen offset:0 nt
    buffer_load_dwordx4 v[172:175], v2, s[24:27], s73 offen offset:256 nt
    buffer_load_dwordx4 v[176:179], v2, s[24:27], s74 offen offset:0 nt
    buffer_load_dwordx4 v[180:183], v2, s[24:27], s74 offen offset:256 nt
    buffer_load_dwordx4 v[184:187], v2, s[24:27], s75 offen offset:0 nt
    buffer_load_dwordx4 v[188:191], v2, s[24:27], s75 offen offset:256 nt
    s_cmp_eq_u32 s62, 0
    s_cbranch_scc1 L_none_15
    s_ff1_i32_b32 s68, s62
    s_bitset0_b32 s62, s68
    v_readlane_b32 s69, v0, s68
    s_lshl_b32 s67, s68, 6
    s_add_u32 s67, s67, s87
    s_nop 1
    s_lshl_b32 s69, s69, 16
    s_add_u32 s65, s69, s76
    s_branch L_go_16
L_none_15:
    s_mov_b32 s65, 138412032
L_go_16:
    buffer_load_dwordx4 v[192:195], v1, s[20:23], s65 offen offset:0 nt
    buffer_load_dwordx4 v[196:199], v1, s[20:23], s65 offen offset:64 nt
    buffer_load_dwordx4 v[200:203], v1, s[20:23], s65 offen offset:128 nt
    buffer_load_dwordx4 v[204:207], v1, s[20:23], s65 offen offset:192 nt
    buffer_load_dwordx4 v[208:211], v1, s[20:23], s65 offen offset:256 nt
    buffer_load_dwordx4 v[212:215], v1, s[20:23], s65 offen offset:320 nt
    buffer_load_dwordx4 v[216:219], v1, s[20:23], s65 offen offset:384 nt
    buffer_load_dwordx4 v[220:223], v1, s[20:23], s65 offen offset:448 nt
    s_add_u32 s73, s65, 0x1000
    s_add_u32 s74, s65, 0x2000
    s_add_u32 s75, s65, 0x3000
    buffer_load_dwordx4 v[224:227], v2, s[24:27], s65 offen offset:0 nt
    buffer_load_dwordx4 v[228:231], v2, s[24:27], s65 offen offset:256 nt
    buffer_load_dwordx4 v[232:235], v2, s[24:27], s73 offen offset:0 nt
    buffer_load_dwordx4 v[236:239], v2, s[24:27], s73 offen offset:256 nt
    buffer_load_dwordx4 v[240:243], v2, s[24:27], s74 offen offset:0 nt
    buffer_load_dwordx4 v[244:247], v2, s[24:27], s74 offen offset:256 nt
    buffer_load_dwordx4 v[248:251], v2, s[24:27], s75 offen offset:0 nt
    buffer_load_dwordx4 v[252:255], v2, s[24:27], s75 offen offset:256 nt
    v_mov_b32 v13, v6
    s_nop 1
    v_permlane16_swap_b32 v6, v13
    v_add_f32 v6, v6, v13
    v_mov_b32 v13, v6
    s_nop 1
    v_permlane32_swap_b32 v6, v13
    v_add_f32 v6, v6, v13
    v_mbcnt_lo_u32_b32 v15, -1, 0
    v_mbcnt_hi_u32_b32 v15, -1, v15
    v_and_b32 v8, 15, v15
    v_lshrrev_b32 v9, 4, v15
    v_lshlrev_b32 v10, 2, v8
    s_lshl_b32 s68, s52, 7
    v_add_u32 v11, s68, v10
    ds_write_b32 v11, v5 offset:0
    ds_write_b32 v11, v6 offset:64
    s_waitcnt lgkmcnt(0)
    s_barrier
    ds_read_b32 v16, v10 offset:0
    ds_read_b32 v20, v10 offset:64
    ds_read_b32 v17, v10 offset:128
    ds_read_b32 v21, v10 offset:192
    ds_read_b32 v18, v10 offset:256
    ds_read_b32 v22, v10 offset:320
    ds_read_b32 v19, v10 offset:384
    ds_read_b32 v23, v10 offset:448
    s_waitcnt lgkmcnt(0)
    v_max3_f32 v12, v16, v17, v18
    v_max_f32 v12, v12, v19
    v_sub_f32 v16, v16, v12
    v_sub_f32 v17, v17, v12
    v_sub_f32 v18, v18, v12
    v_sub_f32 v19, v19, v12
    v_sub_f32 v13, v5, v12
    v_exp_f32 v16, v16
    v_exp_f32 v17, v17
    v_exp_f32 v18, v18
    v_exp_f32 v19, v19
    v_exp_f32 v13, v13
    v_mul_f32 v14, v16, v20
    v_fma_f32 v14, v17, v21, v14
    v_fma_f32 v14, v18, v22, v14
    v_fma_f32 v14, v19, v23, v14
    ds_write_b32 v10, v12 offset:512
    ds_write_b32 v10, v14 offset:576
    v_mul_f32 v64, v13, v64
    v_mul_f32 v65, v13, v65
    v_mul_f32 v66, v13, v66
    v_mul_f32 v67, v13, v67
    v_mul_f32 v68, v13, v68
    v_mul_f32 v69, v13, v69
    v_mul_f32 v70, v13, v70
    v_mul_f32 v71, v13, v71
    v_mul_f32 v72, v13, v72
    v_mul_f32 v73, v13, v73
    v_mul_f32 v74, v13, v74
    v_mul_f32 v75, v13, v75
    v_mul_f32 v76, v13, v76
    v_mul_f32 v77, v13, v77
    v_mul_f32 v78, v13, v78
    v_mul_f32 v79, v13, v79
    v_mul_f32 v80, v13, v80
    v_mul_f32 v81, v13, v81
    v_mul_f32 v82, v13, v82
    v_mul_f32 v83, v13, v83
    v_mul_f32 v84, v13, v84
    v_mul_f32 v85, v13, v85
    v_mul_f32 v86, v13, v86
    v_mul_f32 v87, v13, v87
    v_mul_f32 v88, v13, v88
    v_mul_f32 v89, v13, v89
    v_mul_f32 v90, v13, v90
    v_mul_f32 v91, v13, v91
    v_mul_f32 v92, v13, v92
    v_mul_f32 v93, v13, v93
    v_mul_f32 v94, v13, v94
    v_mul_f32 v95, v13, v95
    v_mul_f32 v96, v13, v96
    v_mul_f32 v97, v13, v97
    v_mul_f32 v98, v13, v98
    v_mul_f32 v99, v13, v99
    v_mul_f32 v100, v13, v100
    v_mul_f32 v101, v13, v101
    v_mul_f32 v102, v13, v102
    v_mul_f32 v103, v13, v103
    v_mul_f32 v104, v13, v104
    v_mul_f32 v105, v13, v105
    v_mul_f32 v106, v13, v106
    v_mul_f32 v107, v13, v107
    v_mul_f32 v108, v13, v108
    v_mul_f32 v109, v13, v109
    v_mul_f32 v110, v13, v110
    v_mul_f32 v111, v13, v111
    v_mul_f32 v112, v13, v112
    v_mul_f32 v113, v13, v113
    v_mul_f32 v114, v13, v114
    v_mul_f32 v115, v13, v115
    v_mul_f32 v116, v13, v116
    v_mul_f32 v117, v13, v117
    v_mul_f32 v118, v13, v118
    v_mul_f32 v119, v13, v119
    v_mul_f32 v120, v13, v120
    v_mul_f32 v121, v13, v121
    v_mul_f32 v122, v13, v122
    v_mul_f32 v123, v13, v123
    v_mul_f32 v124, v13, v124
    v_mul_f32 v125, v13, v125
    v_mul_f32 v126, v13, v126
    v_mul_f32 v127, v13, v127
    s_mul_i32 s68, s52, 16640
    v_mul_u32_u24 v11, 1040, v8
    v_lshl_add_u32 v11, v9, 4, v11
    v_add_u32 v11, s68, v11
    ds_write_b128 v11, v[64:67] offset:1024
    ds_write_b128 v11, v[68:71] offset:1088
    ds_write_b128 v11, v[72:75] offset:1152
    ds_write_b128 v11, v[76:79] offset:1216
    ds_write_b128 v11, v[80:83] offset:1280
    ds_write_b128 v11, v[84:87] offset:1344
    ds_write_b128 v11, v[88:91] offset:1408
    ds_write_b128 v11, v[92:95] offset:1472
    ds_write_b128 v11, v[96:99] offset:1536
    ds_write_b128 v11, v[100:103] offset:1600
    ds_write_b128 v11, v[104:107] offset:1664
    ds_write_b128 v11, v[108:111] offset:1728
    ds_write_b128 v11, v[112:115] offset:1792
    ds_write_b128 v11, v[116:119] offset:1856
    ds_write_b128 v11, v[120:123] offset:1920
    ds_write_b128 v11, v[124:127] offset:1984
    s_waitcnt lgkmcnt(0)
    s_barrier
    s_lshl_b32 s68, s52, 10
    v_lshlrev_b32 v11, 4, v15
    s_mul_i32 s69, s52, 1040
    v_add_u32 v12, s69, v11
    v_add_u32 v11, s68, v11
    s_lshl_b32 s68, s53, 2
    s_add_u32 s68, s68, s57
    s_lshl_b32 s68, s68, 3
    s_add_u32 s68, s68, s56
    s_lshl_b32 s68, s68, 15
    ds_read_b128 v[64:67], v12 offset:1024
    ds_read_b128 v[68:71], v12 offset:17664
    ds_read_b128 v[72:75], v12 offset:34304
    ds_read_b128 v[76:79], v12 offset:50944
    ds_read_b128 v[80:83], v12 offset:5184
    ds_read_b128 v[84:87], v12 offset:21824
    ds_read_b128 v[88:91], v12 offset:38464
    ds_read_b128 v[92:95], v12 offset:55104
    ds_read_b128 v[96:99], v12 offset:9344
    ds_read_b128 v[100:103], v12 offset:25984
    ds_read_b128 v[104:107], v12 offset:42624
    ds_read_b128 v[108:111], v12 offset:59264
    ds_read_b128 v[112:115], v12 offset:13504
    ds_read_b128 v[116:119], v12 offset:30144
    ds_read_b128 v[120:123], v12 offset:46784
    ds_read_b128 v[124:127], v12 offset:63424
    v_lshlrev_b32 v10, 2, v15
    ds_read_b32 v28, v10 offset:512
    s_waitcnt lgkmcnt(0)
    v_add_f32 v64, v64, v68
    v_add_f32 v72, v72, v76
    v_add_f32 v65, v65, v69
    v_add_f32 v73, v73, v77
    v_add_f32 v66, v66, v70
    v_add_f32 v74, v74, v78
    v_add_f32 v67, v67, v71
    v_add_f32 v75, v75, v79
    v_add_f32 v64, v64, v72
    v_add_f32 v65, v65, v73
    v_add_f32 v66, v66, v74
    v_add_f32 v67, v67, v75
    s_add_u32 s69, s68, 0
    buffer_store_dwordx4 v[64:67], v11, s[48:51], s69 offen sc1
    v_add_f32 v80, v80, v84
    v_add_f32 v88, v88, v92
    v_add_f32 v81, v81, v85
    v_add_f32 v89, v89, v93
    v_add_f32 v82, v82, v86
    v_add_f32 v90, v90, v94
    v_add_f32 v83, v83, v87
    v_add_f32 v91, v91, v95
    v_add_f32 v80, v80, v88
    v_add_f32 v81, v81, v89
    v_add_f32 v82, v82, v90
    v_add_f32 v83, v83, v91
    s_add_u32 s69, s68, 4096
    buffer_store_dwordx4 v[80:83], v11, s[48:51], s69 offen sc1
    v_add_f32 v96, v96, v100
    v_add_f32 v104, v104, v108
    v_add_f32 v97, v97, v101
    v_add_f32 v105, v105, v109
    v_add_f32 v98, v98, v102
    v_add_f32 v106, v106, v110
    v_add_f32 v99, v99, v103
    v_add_f32 v107, v107, v111
    v_add_f32 v96, v96, v104
    v_add_f32 v97, v97, v105
    v_add_f32 v98, v98, v106
    v_add_f32 v99, v99, v107
    s_add_u32 s69, s68, 8192
    buffer_store_dwordx4 v[96:99], v11, s[48:51], s69 offen sc1
    v_add_f32 v112, v112, v116
    v_add_f32 v120, v120, v124
    v_add_f32 v113, v113, v117
    v_add_f32 v121, v121, v125
    v_add_f32 v114, v114, v118
    v_add_f32 v122, v122, v126
    v_add_f32 v115, v115, v119
    v_add_f32 v123, v123, v127
    v_add_f32 v112, v112, v120
    v_add_f32 v113, v113, v121
    v_add_f32 v114, v114, v122
    v_add_f32 v115, v115, v123
    s_add_u32 s69, s68, 12288
    buffer_store_dwordx4 v[112:115], v11, s[48:51], s69 offen sc1
    s_add_u32 s69, s68, 0x4000
    s_cmp_lg_u32 s52, 0
    s_cbranch_scc1 L_A_noml
    v_cmp_gt_u32 vcc, 32, v15
    s_and_saveexec_b64 s[78:79], vcc
    buffer_store_dword v28, v10, s[48:51], s69 offen sc1
    s_mov_b64 exec, s[78:79]
L_A_noml:
    s_waitcnt vmcnt(0)
    s_barrier
    v_mov_b32 v64, 0
    v_mov_b32 v65, 0
    v_mov_b32 v66, 0
    v_mov_b32 v67, 0
    v_mov_b32 v68, 0
    v_mov_b32 v69, 0
    v_mov_b32 v70, 0
    v_mov_b32 v71, 0
    v_mov_b32 v72, 0
    v_mov_b32 v73, 0
    v_mov_b32 v74, 0
    v_mov_b32 v75, 0
    v_mov_b32 v76, 0
    v_mov_b32 v77, 0
    v_mov_b32 v78, 0
    v_mov_b32 v79, 0
    v_mov_b32 v80, 0
    v_mov_b32 v81, 0
    v_mov_b32 v82, 0
    v_mov_b32 v83, 0
    v_mov_b32 v84, 0
    v_mov_b32 v85, 0
    v_mov_b32 v86, 0
    v_mov_b32 v87, 0
    v_mov_b32 v88, 0
    v_mov_b32 v89, 0
    v_mov_b32 v90, 0
    v_mov_b32 v91, 0
    v_mov_b32 v92, 0
    v_mov_b32 v93, 0
    v_mov_b32 v94, 0
    v_mov_b32 v95, 0
    v_mov_b32 v96, 0
    v_mov_b32 v97, 0
    v_mov_b32 v98, 0
    v_mov_b32 v99, 0
    v_mov_b32 v100, 0
    v_mov_b32 v101, 0
    v_mov_b32 v102, 0
    v_mov_b32 v103, 0
    v_mov_b32 v104, 0
    v_mov_b32 v105, 0
    v_mov_b32 v106, 0
    v_mov_b32 v107, 0
    v_mov_b32 v108, 0
    v_mov_b32 v109, 0
    v_mov_b32 v110, 0
    v_mov_b32 v111, 0
    v_mov_b32 v112, 0
    v_mov_b32 v113, 0
    v_mov_b32 v114, 0
    v_mov_b32 v115, 0
    v_mov_b32 v116, 0
    v_mov_b32 v117, 0
    v_mov_b32 v118, 0
    v_mov_b32 v119, 0
    v_mov_b32 v120, 0
    v_mov_b32 v121, 0
    v_mov_b32 v122, 0
    v_mov_b32 v123, 0
    v_mov_b32 v124, 0
    v_mov_b32 v125, 0
    v_mov_b32 v126, 0
    v_mov_b32 v127, 0
    v_mov_b32 v5, 0xf149f2ca
    v_mov_b32 v6, 0
    s_cmp_lg_u32 s52, 0
    s_cbranch_scc1 L_B_start
    v_mbcnt_lo_u32_b32 v15, -1, 0
    v_mbcnt_hi_u32_b32 v15, -1, v15
    s_and_b32 s92, s53, 3
    s_lshl_b32 s92, s92, 3
    s_lshl_b32 s68, 1, s92
    v_mov_b32 v28, s68
    s_and_b32 s68, s53, 4
    s_lshl_b32 s69, s57, 6
    s_add_u32 s68, s68, s69
    v_lshlrev_b32 v10, 3, v15
    v_cmp_gt_u32 vcc, 8, v15
    s_and_saveexec_b64 s[78:79], vcc
    buffer_atomic_add v28, v10, s[44:47], s68 offen sc0 sc1
    s_waitcnt vmcnt(0)
    v_lshrrev_b32 v28, s92, v28
    v_and_b32 v28, 0xff, v28
    v_cmp_eq_u32 vcc, s100, v28
    s_mov_b64 exec, s[78:79]
    s_and_b32 s90, vcc_lo, 0xff
    s_branch L_B_start
L_noA:
    v_mbcnt_lo_u32_b32 v16, -1, 0
    v_mbcnt_hi_u32_b32 v16, -1, v16
    v_and_b32 v17, 1, v16
    v_lshrrev_b32 v18, 4, v16
    v_lshlrev_b32 v17, 9, v17
    v_lshl_add_u32 v17, v18, 4, v17
    s_lshl_b32 s68, s54, 13
    s_lshl_b32 s69, s53, 10
    s_add_u32 s68, s68, s69
    buffer_load_dwordx4 v[32:35], v17, s[28:31], s68 offen offset:0
    buffer_load_dwordx4 v[36:39], v17, s[28:31], s68 offen offset:64
    buffer_load_dwordx4 v[40:43], v17, s[28:31], s68 offen offset:128
    buffer_load_dwordx4 v[44:47], v17, s[28:31], s68 offen offset:192
    buffer_load_dwordx4 v[48:51], v17, s[28:31], s68 offen offset:256
    buffer_load_dwordx4 v[52:55], v17, s[28:31], s68 offen offset:320
    buffer_load_dwordx4 v[56:59], v17, s[28:31], s68 offen offset:384
    buffer_load_dwordx4 v[60:63], v17, s[28:31], s68 offen offset:448
    v_lshlrev_b32 v18, 2, v18
    v_sub_u32 v4, s97, v18
    s_mov_b32 s62, s96
    s_cmp_eq_u32 s62, 0
    s_cbranch_scc1 L_none_17
    s_ff1_i32_b32 s68, s62
    s_bitset0_b32 s62, s68
    v_readlane_b32 s69, v0, s68
    s_lshl_b32 s66, s68, 6
    s_add_u32 s66, s66, s87
    s_nop 1
    s_lshl_b32 s69, s69, 16
    s_add_u32 s64, s69, s76
    s_branch L_go_18
L_none_17:
    s_mov_b32 s64, 138412032
L_go_18:
    buffer_load_dwordx4 v[128:131], v1, s[20:23], s64 offen offset:0 nt
    buffer_load_dwordx4 v[132:135], v1, s[20:23], s64 offen offset:64 nt
    buffer_load_dwordx4 v[136:139], v1, s[20:23], s64 offen offset:128 nt
    buffer_load_dwordx4 v[140:143], v1, s[20:23], s64 offen offset:192 nt
    buffer_load_dwordx4 v[144:147], v1, s[20:23], s64 offen offset:256 nt
    buffer_load_dwordx4 v[148:151], v1, s[20:23], s64 offen offset:320 nt
    buffer_load_dwordx4 v[152:155], v1, s[20:23], s64 offen offset:384 nt
    buffer_load_dwordx4 v[156:159], v1, s[20:23], s64 offen offset:448 nt
    s_add_u32 s73, s64, 0x1000
    s_add_u32 s74, s64, 0x2000
    s_add_u32 s75, s64, 0x3000
    buffer_load_dwordx4 v[160:163], v2, s[24:27], s64 offen offset:0 nt
    buffer_load_dwordx4 v[164:167], v2, s[24:27], s64 offen offset:256 nt
    buffer_load_dwordx4 v[168:171], v2, s[24:27], s73 offen offset:0 nt
    buffer_load_dwordx4 v[172:175], v2, s[24:27], s73 offen offset:256 nt
    buffer_load_dwordx4 v[176:179], v2, s[24:27], s74 offen offset:0 nt
    buffer_load_dwordx4 v[180:183], v2, s[24:27], s74 offen offset:256 nt
    buffer_load_dwordx4 v[184:187], v2, s[24:27], s75 offen offset:0 nt
    buffer_load_dwordx4 v[188:191], v2, s[24:27], s75 offen offset:256 nt
    s_cmp_eq_u32 s62, 0
    s_cbranch_scc1 L_none_19
    s_ff1_i32_b32 s68, s62
    s_bitset0_b32 s62, s68
    v_readlane_b32 s69, v0, s68
    s_lshl_b32 s67, s68, 6
    s_add_u32 s67, s67, s87
    s_nop 1
    s_lshl_b32 s69, s69, 16
    s_add_u32 s65, s69, s76
    s_branch L_go_20
L_none_19:
    s_mov_b32 s65, 138412032
L_go_20:
    buffer_load_dwordx4 v[192:195], v1, s[20:23], s65 offen offset:0 nt
    buffer_load_dwordx4 v[196:199], v1, s[20:23], s65 offen offset:64 nt
    buffer_load_dwordx4 v[200:203], v1, s[20:23], s65 offen offset:128 nt
    buffer_load_dwordx4 v[204:207], v1, s[20:23], s65 offen offset:192 nt
    buffer_load_dwordx4 v[208:211], v1, s[20:23], s65 offen offset:256 nt
    buffer_load_dwordx4 v[212:215], v1, s[20:23], s65 offen offset:320 nt
    buffer_load_dwordx4 v[216:219], v1, s[20:23], s65 offen offset:384 nt
    buffer_load_dwordx4 v[220:223], v1, s[20:23], s65 offen offset:448 nt
    s_add_u32 s73, s65, 0x1000
    s_add_u32 s74, s65, 0x2000
    s_add_u32 s75, s65, 0x3000
    buffer_load_dwordx4 v[224:227], v2, s[24:27], s65 offen offset:0 nt
    buffer_load_dwordx4 v[228:231], v2, s[24:27], s65 offen offset:256 nt
    buffer_load_dwordx4 v[232:235], v2, s[24:27], s73 offen offset:0 nt
    buffer_load_dwordx4 v[236:239], v2, s[24:27], s73 offen offset:256 nt
    buffer_load_dwordx4 v[240:243], v2, s[24:27], s74 offen offset:0 nt
    buffer_load_dwordx4 v[244:247], v2, s[24:27], s74 offen offset:256 nt
    buffer_load_dwordx4 v[248:251], v2, s[24:27], s75 offen offset:0 nt
    buffer_load_dwordx4 v[252:255], v2, s[24:27], s75 offen offset:256 nt
L_B_start:
    s_bcnt1_i32_b32 s63, s96
    s_cmp_lg_u32 s63, 0
    s_cbranch_scc1 L_B_go
    v_mov_b32 v13, 0
    buffer_load_dword v7, v13, s[44:47], s3 offen sc1
    s_branch L_B_loopdone
L_B_go:
L_loop_21:
    s_cmp_lg_u32 s63, 1
    s_cbranch_scc1 L_nopoll_23
    v_mov_b32 v13, 0
    buffer_load_dword v7, v13, s[44:47], s3 offen sc1
L_nopoll_23:
    s_waitcnt vmcnt(24)
    v_mfma_f32_16x16x32_bf16 v[8:11], v[128:131], v[32:35], 0
    v_mfma_f32_16x16x32_bf16 v[8:11], v[132:135], v[36:39], v[8:11]
    v_mfma_f32_16x16x32_bf16 v[8:11], v[136:139], v[40:43], v[8:11]
    v_mfma_f32_16x16x32_bf16 v[8:11], v[140:143], v[44:47], v[8:11]
    v_mfma_f32_16x16x32_bf16 v[8:11], v[144:147], v[48:51], v[8:11]
    v_mfma_f32_16x16x32_bf16 v[8:11], v[148:151], v[52:55], v[8:11]
    v_mfma_f32_16x16x32_bf16 v[8:11], v[152:155], v[56:59], v[8:11]
    v_mfma_f32_16x16x32_bf16 v[8:11], v[156:159], v[60:63], v[8:11]
    v_subrev_u32 v12, s66, v4
    s_cmp_eq_u32 s62, 0
    s_cbranch_scc1 L_none_24
    s_ff1_i32_b32 s68, s62
    s_bitset0_b32 s62, s68
    v_readlane_b32 s69, v0, s68
    s_lshl_b32 s66, s68, 6
    s_add_u32 s66, s66, s87
    s_nop 1
    s_lshl_b32 s69, s69, 16
    s_add_u32 s64, s69, s76
    s_branch L_go_25
L_none_24:
    s_mov_b32 s64, 138412032
L_go_25:
    buffer_load_dwordx4 v[128:131], v1, s[20:23], s64 offen offset:0 nt
    buffer_load_dwordx4 v[132:135], v1, s[20:23], s64 offen offset:64 nt
    buffer_load_dwordx4 v[136:139], v1, s[20:23], s64 offen offset:128 nt
    buffer_load_dwordx4 v[140:143], v1, s[20:23], s64 offen offset:192 nt
    buffer_load_dwordx4 v[144:147], v1, s[20:23], s64 offen offset:256 nt
    buffer_load_dwordx4 v[148:151], v1, s[20:23], s64 offen offset:320 nt
    buffer_load_dwordx4 v[152:155], v1, s[20:23], s64 offen offset:384 nt
    buffer_load_dwordx4 v[156:159], v1, s[20:23], s64 offen offset:448 nt
    v_mov_b32 v13, 0xff61b1e6
    v_cmp_lt_i32 vcc, 0, v12
    v_mul_f32 v8, s98, v8
    v_mul_f32 v9, s98, v9
    v_cndmask_b32 v8, v13, v8, vcc
    v_cmp_lt_i32 vcc, 1, v12
    v_mul_f32 v10, s98, v10
    v_mul_f32 v11, s98, v11
    v_cndmask_b32 v9, v13, v9, vcc
    v_cmp_lt_i32 vcc, 2, v12
    s_nop 1
    v_cndmask_b32 v10, v13, v10, vcc
    v_cmp_lt_i32 vcc, 3, v12
    s_nop 1
    v_cndmask_b32 v11, v13, v11, vcc
    v_max3_f32 v12, v8, v9, v10
    v_max_f32 v12, v12, v11
    v_mov_b32 v13, v12
    s_nop 1
    v_permlane16_swap_b32 v12, v13
    v_max_f32 v12, v12, v13
    v_mov_b32 v13, v12
    s_nop 1
    v_permlane32_swap_b32 v12, v13
    v_max3_f32 v12, v12, v13, v5
    v_sub_f32 v13, v5, v12
    v_exp_f32 v13, v13
    v_mov_b32 v5, v12
    v_sub_f32 v8, v8, v12
    v_sub_f32 v9, v9, v12
    v_sub_f32 v10, v10, v12
    v_sub_f32 v11, v11, v12
    v_exp_f32 v8, v8
    v_exp_f32 v9, v9
    v_exp_f32 v10, v10
    v_exp_f32 v11, v11
    v_cmp_neq_f32 vcc, 1.0, v13
    v_add_f32 v12, v8, v9
    v_add_f32 v12, v12, v10
    v_add_f32 v12, v12, v11
    v_fma_f32 v6, v6, v13, v12
    v_cvt_pk_bf16_f32 v14, v8, v9
    v_cvt_pk_bf16_f32 v15, v10, v11
    s_cbranch_vccz L_nors_26
    v_mul_f32 v64, v13, v64
    v_mul_f32 v65, v13, v65
    v_mul_f32 v66, v13, v66
    v_mul_f32 v67, v13, v67
    v_mul_f32 v68, v13, v68
    v_mul_f32 v69, v13, v69
    v_mul_f32 v70, v13, v70
    v_mul_f32 v71, v13, v71
    v_mul_f32 v72, v13, v72
    v_mul_f32 v73, v13, v73
    v_mul_f32 v74, v13, v74
    v_mul_f32 v75, v13, v75
    v_mul_f32 v76, v13, v76
    v_mul_f32 v77, v13, v77
    v_mul_f32 v78, v13, v78
    v_mul_f32 v79, v13, v79
    v_mul_f32 v80, v13, v80
    v_mul_f32 v81, v13, v81
    v_mul_f32 v82, v13, v82
    v_mul_f32 v83, v13, v83
    v_mul_f32 v84, v13, v84
    v_mul_f32 v85, v13, v85
    v_mul_f32 v86, v13, v86
    v_mul_f32 v87, v13, v87
    v_mul_f32 v88, v13, v88
    v_mul_f32 v89, v13, v89
    v_mul_f32 v90, v13, v90
    v_mul_f32 v91, v13, v91
    v_mul_f32 v92, v13, v92
    v_mul_f32 v93, v13, v93
    v_mul_f32 v94, v13, v94
    v_mul_f32 v95, v13, v95
    v_mul_f32 v96, v13, v96
    v_mul_f32 v97, v13, v97
    v_mul_f32 v98, v13, v98
    v_mul_f32 v99, v13, v99
    v_mul_f32 v100, v13, v100
    v_mul_f32 v101, v13, v101
    v_mul_f32 v102, v13, v102
    v_mul_f32 v103, v13, v103
    v_mul_f32 v104, v13, v104
    v_mul_f32 v105, v13, v105
    v_mul_f32 v106, v13, v106
    v_mul_f32 v107, v13, v107
    v_mul_f32 v108, v13, v108
    v_mul_f32 v109, v13, v109
    v_mul_f32 v110, v13, v110
    v_mul_f32 v111, v13, v111
    v_mul_f32 v112, v13, v112
    v_mul_f32 v113, v13, v113
    v_mul_f32 v114, v13, v114
    v_mul_f32 v115, v13, v115
    v_mul_f32 v116, v13, v116
    v_mul_f32 v117, v13, v117
    v_mul_f32 v118, v13, v118
    v_mul_f32 v119, v13, v119
    v_mul_f32 v120, v13, v120
    v_mul_f32 v121, v13, v121
    v_mul_f32 v122, v13, v122
    v_mul_f32 v123, v13, v123
    v_mul_f32 v124, v13, v124
    v_mul_f32 v125, v13, v125
    v_mul_f32 v126, v13, v126
    v_mul_f32 v127, v13, v127
L_nors_26:
    s_waitcnt vmcnt(24)
    v_perm_b32 v16, v168, v160, s70
    v_perm_b32 v17, v184, v176, s70
    v_perm_b32 v18, v168, v160, s71
    v_perm_b32 v19, v184, v176, s71
    v_perm_b32 v20, v169, v161, s70
    v_perm_b32 v21, v185, v177, s70
    v_perm_b32 v22, v169, v161, s71
    v_perm_b32 v23, v185, v177, s71
    v_mfma_f32_16x16x16_bf16 v[64:67], v[16:17], v[14:15], v[64:67]
    v_mfma_f32_16x16x16_bf16 v[68:71], v[18:19], v[14:15], v[68:71]
    v_perm_b32 v24, v170, v162, s70
    v_perm_b32 v25, v186, v178, s70
    v_perm_b32 v26, v170, v162, s71
    v_perm_b32 v27, v186, v178, s71
    v_mfma_f32_16x16x16_bf16 v[72:75], v[20:21], v[14:15], v[72:75]
    v_mfma_f32_16x16x16_bf16 v[76:79], v[22:23], v[14:15], v[76:79]
    v_perm_b32 v28, v171, v163, s70
    v_perm_b32 v29, v187, v179, s70
    v_perm_b32 v30, v171, v163, s71
    v_perm_b32 v31, v187, v179, s71
    v_mfma_f32_16x16x16_bf16 v[80:83], v[24:25], v[14:15], v[80:83]
    v_mfma_f32_16x16x16_bf16 v[84:87], v[26:27], v[14:15], v[84:87]
    v_perm_b32 v16, v172, v164, s70
    v_perm_b32 v17, v188, v180, s70
    v_perm_b32 v18, v172, v164, s71
    v_perm_b32 v19, v188, v180, s71
    v_mfma_f32_16x16x16_bf16 v[88:91], v[28:29], v[14:15], v[88:91]
    v_mfma_f32_16x16x16_bf16 v[92:95], v[30:31], v[14:15], v[92:95]
    v_perm_b32 v20, v173, v165, s70
    v_perm_b32 v21, v189, v181, s70
    v_perm_b32 v22, v173, v165, s71
    v_perm_b32 v23, v189, v181, s71
    v_mfma_f32_16x16x16_bf16 v[96:99], v[16:17], v[14:15], v[96:99]
    v_mfma_f32_16x16x16_bf16 v[100:103], v[18:19], v[14:15], v[100:103]
    v_perm_b32 v24, v174, v166, s70
    v_perm_b32 v25, v190, v182, s70
    v_perm_b32 v26, v174, v166, s71
    v_perm_b32 v27, v190, v182, s71
    v_mfma_f32_16x16x16_bf16 v[104:107], v[20:21], v[14:15], v[104:107]
    v_mfma_f32_16x16x16_bf16 v[108:111], v[22:23], v[14:15], v[108:111]
    v_perm_b32 v28, v175, v167, s70
    v_perm_b32 v29, v191, v183, s70
    v_perm_b32 v30, v175, v167, s71
    v_perm_b32 v31, v191, v183, s71
    v_mfma_f32_16x16x16_bf16 v[112:115], v[24:25], v[14:15], v[112:115]
    v_mfma_f32_16x16x16_bf16 v[116:119], v[26:27], v[14:15], v[116:119]
    s_add_u32 s73, s64, 0x1000
    s_add_u32 s74, s64, 0x2000
    s_add_u32 s75, s64, 0x3000
    buffer_load_dwordx4 v[160:163], v2, s[24:27], s64 offen offset:0 nt
    buffer_load_dwordx4 v[164:167], v2, s[24:27], s64 offen offset:256 nt
    buffer_load_dwordx4 v[168:171], v2, s[24:27], s73 offen offset:0 nt
    buffer_load_dwordx4 v[172:175], v2, s[24:27], s73 offen offset:256 nt
    buffer_load_dwordx4 v[176:179], v2, s[24:27], s74 offen offset:0 nt
    buffer_load_dwordx4 v[180:183], v2, s[24:27], s74 offen offset:256 nt
    buffer_load_dwordx4 v[184:187], v2, s[24:27], s75 offen offset:0 nt
    buffer_load_dwordx4 v[188:191], v2, s[24:27], s75 offen offset:256 nt
    v_mfma_f32_16x16x16_bf16 v[120:123], v[28:29], v[14:15], v[120:123]
    v_mfma_f32_16x16x16_bf16 v[124:127], v[30:31], v[14:15], v[124:127]
    s_sub_u32 s63, s63, 1
    s_cmp_eq_u32 s63, 0
    s_cbranch_scc1 L_ldone_22
    s_cmp_lg_u32 s63, 1
    s_cbranch_scc1 L_nopoll_27
    v_mov_b32 v13, 0
    buffer_load_dword v7, v13, s[44:47], s3 offen sc1
L_nopoll_27:
    s_waitcnt vmcnt(24)
    v_mfma_f32_16x16x32_bf16 v[8:11], v[192:195], v[32:35], 0
    v_mfma_f32_16x16x32_bf16 v[8:11], v[196:199], v[36:39], v[8:11]
    v_mfma_f32_16x16x32_bf16 v[8:11], v[200:203], v[40:43], v[8:11]
    v_mfma_f32_16x16x32_bf16 v[8:11], v[204:207], v[44:47], v[8:11]
    v_mfma_f32_16x16x32_bf16 v[8:11], v[208:211], v[48:51], v[8:11]
    v_mfma_f32_16x16x32_bf16 v[8:11], v[212:215], v[52:55], v[8:11]
    v_mfma_f32_16x16x32_bf16 v[8:11], v[216:219], v[56:59], v[8:11]
    v_mfma_f32_16x16x32_bf16 v[8:11], v[220:223], v[60:63], v[8:11]
    v_subrev_u32 v12, s67, v4
    s_cmp_eq_u32 s62, 0
    s_cbranch_scc1 L_none_28
    s_ff1_i32_b32 s68, s62
    s_bitset0_b32 s62, s68
    v_readlane_b32 s69, v0, s68
    s_lshl_b32 s67, s68, 6
    s_add_u32 s67, s67, s87
    s_nop 1
    s_lshl_b32 s69, s69, 16
    s_add_u32 s65, s69, s76
    s_branch L_go_29
L_none_28:
    s_mov_b32 s65, 138412032
L_go_29:
    buffer_load_dwordx4 v[192:195], v1, s[20:23], s65 offen offset:0 nt
    buffer_load_dwordx4 v[196:199], v1, s[20:23], s65 offen offset:64 nt
    buffer_load_dwordx4 v[200:203], v1, s[20:23], s65 offen offset:128 nt
    buffer_load_dwordx4 v[204:207], v1, s[20:23], s65 offen offset:192 nt
    buffer_load_dwordx4 v[208:211], v1, s[20:23], s65 offen offset:256 nt
    buffer_load_dwordx4 v[212:215], v1, s[20:23], s65 offen offset:320 nt
    buffer_load_dwordx4 v[216:219], v1, s[20:23], s65 offen offset:384 nt
    buffer_load_dwordx4 v[220:223], v1, s[20:23], s65 offen offset:448 nt
    v_mov_b32 v13, 0xff61b1e6
    v_cmp_lt_i32 vcc, 0, v12
    v_mul_f32 v8, s98, v8
    v_mul_f32 v9, s98, v9
    v_cndmask_b32 v8, v13, v8, vcc
    v_cmp_lt_i32 vcc, 1, v12
    v_mul_f32 v10, s98, v10
    v_mul_f32 v11, s98, v11
    v_cndmask_b32 v9, v13, v9, vcc
    v_cmp_lt_i32 vcc, 2, v12
    s_nop 1
    v_cndmask_b32 v10, v13, v10, vcc
    v_cmp_lt_i32 vcc, 3, v12
    s_nop 1
    v_cndmask_b32 v11, v13, v11, vcc
    v_max3_f32 v12, v8, v9, v10
    v_max_f32 v12, v12, v11
    v_mov_b32 v13, v12
    s_nop 1
    v_permlane16_swap_b32 v12, v13
    v_max_f32 v12, v12, v13
    v_mov_b32 v13, v12
    s_nop 1
    v_permlane32_swap_b32 v12, v13
    v_max3_f32 v12, v12, v13, v5
    v_sub_f32 v13, v5, v12
    v_exp_f32 v13, v13
    v_mov_b32 v5, v12
    v_sub_f32 v8, v8, v12
    v_sub_f32 v9, v9, v12
    v_sub_f32 v10, v10, v12
    v_sub_f32 v11, v11, v12
    v_exp_f32 v8, v8
    v_exp_f32 v9, v9
    v_exp_f32 v10, v10
    v_exp_f32 v11, v11
    v_cmp_neq_f32 vcc, 1.0, v13
    v_add_f32 v12, v8, v9
    v_add_f32 v12, v12, v10
    v_add_f32 v12, v12, v11
    v_fma_f32 v6, v6, v13, v12
    v_cvt_pk_bf16_f32 v14, v8, v9
    v_cvt_pk_bf16_f32 v15, v10, v11
    s_cbranch_vccz L_nors_30
    v_mul_f32 v64, v13, v64
    v_mul_f32 v65, v13, v65
    v_mul_f32 v66, v13, v66
    v_mul_f32 v67, v13, v67
    v_mul_f32 v68, v13, v68
    v_mul_f32 v69, v13, v69
    v_mul_f32 v70, v13, v70
    v_mul_f32 v71, v13, v71
    v_mul_f32 v72, v13, v72
    v_mul_f32 v73, v13, v73
    v_mul_f32 v74, v13, v74
    v_mul_f32 v75, v13, v75
    v_mul_f32 v76, v13, v76
    v_mul_f32 v77, v13, v77
    v_mul_f32 v78, v13, v78
    v_mul_f32 v79, v13, v79
    v_mul_f32 v80, v13, v80
    v_mul_f32 v81, v13, v81
    v_mul_f32 v82, v13, v82
    v_mul_f32 v83, v13, v83
    v_mul_f32 v84, v13, v84
    v_mul_f32 v85, v13, v85
    v_mul_f32 v86, v13, v86
    v_mul_f32 v87, v13, v87
    v_mul_f32 v88, v13, v88
    v_mul_f32 v89, v13, v89
    v_mul_f32 v90, v13, v90
    v_mul_f32 v91, v13, v91
    v_mul_f32 v92, v13, v92
    v_mul_f32 v93, v13, v93
    v_mul_f32 v94, v13, v94
    v_mul_f32 v95, v13, v95
    v_mul_f32 v96, v13, v96
    v_mul_f32 v97, v13, v97
    v_mul_f32 v98, v13, v98
    v_mul_f32 v99, v13, v99
    v_mul_f32 v100, v13, v100
    v_mul_f32 v101, v13, v101
    v_mul_f32 v102, v13, v102
    v_mul_f32 v103, v13, v103
    v_mul_f32 v104, v13, v104
    v_mul_f32 v105, v13, v105
    v_mul_f32 v106, v13, v106
    v_mul_f32 v107, v13, v107
    v_mul_f32 v108, v13, v108
    v_mul_f32 v109, v13, v109
    v_mul_f32 v110, v13, v110
    v_mul_f32 v111, v13, v111
    v_mul_f32 v112, v13, v112
    v_mul_f32 v113, v13, v113
    v_mul_f32 v114, v13, v114
    v_mul_f32 v115, v13, v115
    v_mul_f32 v116, v13, v116
    v_mul_f32 v117, v13, v117
    v_mul_f32 v118, v13, v118
    v_mul_f32 v119, v13, v119
    v_mul_f32 v120, v13, v120
    v_mul_f32 v121, v13, v121
    v_mul_f32 v122, v13, v122
    v_mul_f32 v123, v13, v123
    v_mul_f32 v124, v13, v124
    v_mul_f32 v125, v13, v125
    v_mul_f32 v126, v13, v126
    v_mul_f32 v127, v13, v127
L_nors_30:
    s_waitcnt vmcnt(24)
    v_perm_b32 v16, v232, v224, s70
    v_perm_b32 v17, v248, v240, s70
    v_perm_b32 v18, v232, v224, s71
    v_perm_b32 v19, v248, v240, s71
    v_perm_b32 v20, v233, v225, s70
    v_perm_b32 v21, v249, v241, s70
    v_perm_b32 v22, v233, v225, s71
    v_perm_b32 v23, v249, v241, s71
    v_mfma_f32_16x16x16_bf16 v[64:67], v[16:17], v[14:15], v[64:67]
    v_mfma_f32_16x16x16_bf16 v[68:71], v[18:19], v[14:15], v[68:71]
    v_perm_b32 v24, v234, v226, s70
    v_perm_b32 v25, v250, v242, s70
    v_perm_b32 v26, v234, v226, s71
    v_perm_b32 v27, v250, v242, s71
    v_mfma_f32_16x16x16_bf16 v[72:75], v[20:21], v[14:15], v[72:75]
    v_mfma_f32_16x16x16_bf16 v[76:79], v[22:23], v[14:15], v[76:79]
    v_perm_b32 v28, v235, v227, s70
    v_perm_b32 v29, v251, v243, s70
    v_perm_b32 v30, v235, v227, s71
    v_perm_b32 v31, v251, v243, s71
    v_mfma_f32_16x16x16_bf16 v[80:83], v[24:25], v[14:15], v[80:83]
    v_mfma_f32_16x16x16_bf16 v[84:87], v[26:27], v[14:15], v[84:87]
    v_perm_b32 v16, v236, v228, s70
    v_perm_b32 v17, v252, v244, s70
    v_perm_b32 v18, v236, v228, s71
    v_perm_b32 v19, v252, v244, s71
    v_mfma_f32_16x16x16_bf16 v[88:91], v[28:29], v[14:15], v[88:91]
    v_mfma_f32_16x16x16_bf16 v[92:95], v[30:31], v[14:15], v[92:95]
    v_perm_b32 v20, v237, v229, s70
    v_perm_b32 v21, v253, v245, s70
    v_perm_b32 v22, v237, v229, s71
    v_perm_b32 v23, v253, v245, s71
    v_mfma_f32_16x16x16_bf16 v[96:99], v[16:17], v[14:15], v[96:99]
    v_mfma_f32_16x16x16_bf16 v[100:103], v[18:19], v[14:15], v[100:103]
    v_perm_b32 v24, v238, v230, s70
    v_perm_b32 v25, v254, v246, s70
    v_perm_b32 v26, v238, v230, s71
    v_perm_b32 v27, v254, v246, s71
    v_mfma_f32_16x16x16_bf16 v[104:107], v[20:21], v[14:15], v[104:107]
    v_mfma_f32_16x16x16_bf16 v[108:111], v[22:23], v[14:15], v[108:111]
    v_perm_b32 v28, v239, v231, s70
    v_perm_b32 v29, v255, v247, s70
    v_perm_b32 v30, v239, v231, s71
    v_perm_b32 v31, v255, v247, s71
    v_mfma_f32_16x16x16_bf16 v[112:115], v[24:25], v[14:15], v[112:115]
    v_mfma_f32_16x16x16_bf16 v[116:119], v[26:27], v[14:15], v[116:119]
    s_add_u32 s73, s65, 0x1000
    s_add_u32 s74, s65, 0x2000
    s_add_u32 s75, s65, 0x3000
    buffer_load_dwordx4 v[224:227], v2, s[24:27], s65 offen offset:0 nt
    buffer_load_dwordx4 v[228:231], v2, s[24:27], s65 offen offset:256 nt
    buffer_load_dwordx4 v[232:235], v2, s[24:27], s73 offen offset:0 nt
    buffer_load_dwordx4 v[236:239], v2, s[24:27], s73 offen offset:256 nt
    buffer_load_dwordx4 v[240:243], v2, s[24:27], s74 offen offset:0 nt
    buffer_load_dwordx4 v[244:247], v2, s[24:27], s74 offen offset:256 nt
    buffer_load_dwordx4 v[248:251], v2, s[24:27], s75 offen offset:0 nt
    buffer_load_dwordx4 v[252:255], v2, s[24:27], s75 offen offset:256 nt
    v_mfma_f32_16x16x16_bf16 v[120:123], v[28:29], v[14:15], v[120:123]
    v_mfma_f32_16x16x16_bf16 v[124:127], v[30:31], v[14:15], v[124:127]
    s_sub_u32 s63, s63, 1
    s_cmp_lg_u32 s63, 0
    s_cbranch_scc1 L_loop_21
L_ldone_22:
L_B_loopdone:
    s_waitcnt vmcnt(0)
    s_mov_b32 s91, s54
    s_mov_b32 s101, s55
    s_mov_b32 s89, 1
    v_mbcnt_lo_u32_b32 v15, -1, 0
    v_mbcnt_hi_u32_b32 v15, -1, v15
    v_mov_b32 v25, 0
    v_and_b32 v24, 15, v15
    v_lshrrev_b32 v26, 4, v15
    s_and_b32 s68, s52, 1
    s_lshl_b32 s69, s68, 9
    v_lshlrev_b32 v27, 7, v26
    v_lshl_add_u32 v24, v24, 2, v27
    v_add_u32 v24, s69, v24
    v_and_b32 v27, 3, v15
    v_lshlrev_b32 v27, 4, v27
    v_lshl_add_u32 v27, v26, 2, v27
    v_bfe_u32 v26, v15, 2, 2
    v_lshl_add_u32 v26, v26, 6, v27
    s_lshl_b32 s69, s68, 8
    v_add_u32 v26, s69, v26
    s_cmp_eq_u32 s86, 0
    s_cbranch_scc1 L_B_early
    v_readfirstlane_b32 s68, v7
    s_and_b32 s94, s53, 3
    s_lshl_b32 s94, s94, 3
    s_lshr_b32 s68, s68, s94
    s_and_b32 s68, s68, 0xff
    s_cmp_eq_u32 s68, s86
    s_cselect_b32 s89, 1, 0
    s_cbranch_scc0 L_B_noearly
L_B_early:
    s_and_b32 s92, s91, 7
    s_lshl_b32 s92, s92, 1
    s_add_u32 s92, s92, s88
    s_lshl_b32 s93, s53, 2
    s_add_u32 s93, s93, s101
    s_lshl_b32 s93, s93, 18
    s_lshl_b32 s94, s92, 10
    s_add_u32 s94, s94, s93
    s_lshl_b32 s95, s92, 2
    s_add_u32 s95, s95, s93
    s_add_u32 s95, s95, 0x4000
    s_bitcmp1_b32 s77, 0
    s_cbranch_scc0 L_ina_31
    buffer_load_dword v32, v24, s[48:51], s94 offen sc1
    buffer_load_dword v33, v24, s[48:51], s94 offen offset:64 sc1
    buffer_load_dword v34, v25, s[48:51], s95 offen sc1
    buffer_load_dword v35, v25, s[48:51], s95 offen offset:64 sc1
    s_branch L_nxt_32
L_ina_31:
    v_mov_b32 v32, 0
    v_mov_b32 v33, 0
    v_mov_b32 v34, 0xf149f2ca
    v_mov_b32 v35, 0
L_nxt_32:
    s_add_u32 s94, s94, 32768
    s_add_u32 s95, s95, 32768
    s_bitcmp1_b32 s77, 1
    s_cbranch_scc0 L_ina_33
    buffer_load_dword v36, v24, s[48:51], s94 offen sc1
    buffer_load_dword v37, v24, s[48:51], s94 offen offset:64 sc1
    buffer_load_dword v38, v25, s[48:51], s95 offen sc1
    buffer_load_dword v39, v25, s[48:51], s95 offen offset:64 sc1
    s_branch L_nxt_34
L_ina_33:
    v_mov_b32 v36, 0
    v_mov_b32 v37, 0
    v_mov_b32 v38, 0xf149f2ca
    v_mov_b32 v39, 0
L_nxt_34:
    s_add_u32 s94, s94, 32768
    s_add_u32 s95, s95, 32768
    s_bitcmp1_b32 s77, 2
    s_cbranch_scc0 L_ina_35
    buffer_load_dword v40, v24, s[48:51], s94 offen sc1
    buffer_load_dword v41, v24, s[48:51], s94 offen offset:64 sc1
    buffer_load_dword v42, v25, s[48:51], s95 offen sc1
    buffer_load_dword v43, v25, s[48:51], s95 offen offset:64 sc1
    s_branch L_nxt_36
L_ina_35:
    v_mov_b32 v40, 0
    v_mov_b32 v41, 0
    v_mov_b32 v42, 0xf149f2ca
    v_mov_b32 v43, 0
L_nxt_36:
    s_add_u32 s94, s94, 32768
    s_add_u32 s95, s95, 32768
    s_bitcmp1_b32 s77, 3
    s_cbranch_scc0 L_ina_37
    buffer_load_dword v44, v24, s[48:51], s94 offen sc1
    buffer_load_dword v45, v24, s[48:51], s94 offen offset:64 sc1
    buffer_load_dword v46, v25, s[48:51], s95 offen sc1
    buffer_load_dword v47, v25, s[48:51], s95 offen offset:64 sc1
    s_branch L_nxt_38
L_ina_37:
    v_mov_b32 v44, 0
    v_mov_b32 v45, 0
    v_mov_b32 v46, 0xf149f2ca
    v_mov_b32 v47, 0
L_nxt_38:
    s_add_u32 s94, s94, 32768
    s_add_u32 s95, s95, 32768
    s_bitcmp1_b32 s77, 4
    s_cbranch_scc0 L_ina_39
    buffer_load_dword v48, v24, s[48:51], s94 offen sc1
    buffer_load_dword v49, v24, s[48:51], s94 offen offset:64 sc1
    buffer_load_dword v50, v25, s[48:51], s95 offen sc1
    buffer_load_dword v51, v25, s[48:51], s95 offen offset:64 sc1
    s_branch L_nxt_40
L_ina_39:
    v_mov_b32 v48, 0
    v_mov_b32 v49, 0
    v_mov_b32 v50, 0xf149f2ca
    v_mov_b32 v51, 0
L_nxt_40:
    s_add_u32 s94, s94, 32768
    s_add_u32 s95, s95, 32768
    s_bitcmp1_b32 s77, 5
    s_cbranch_scc0 L_ina_41
    buffer_load_dword v52, v24, s[48:51], s94 offen sc1
    buffer_load_dword v53, v24, s[48:51], s94 offen offset:64 sc1
    buffer_load_dword v54, v25, s[48:51], s95 offen sc1
    buffer_load_dword v55, v25, s[48:51], s95 offen offset:64 sc1
    s_branch L_nxt_42
L_ina_41:
    v_mov_b32 v52, 0
    v_mov_b32 v53, 0
    v_mov_b32 v54, 0xf149f2ca
    v_mov_b32 v55, 0
L_nxt_42:
    s_add_u32 s94, s94, 32768
    s_add_u32 s95, s95, 32768
    s_bitcmp1_b32 s77, 6
    s_cbranch_scc0 L_ina_43
    buffer_load_dword v56, v24, s[48:51], s94 offen sc1
    buffer_load_dword v57, v24, s[48:51], s94 offen offset:64 sc1
    buffer_load_dword v58, v25, s[48:51], s95 offen sc1
    buffer_load_dword v59, v25, s[48:51], s95 offen offset:64 sc1
    s_branch L_nxt_44
L_ina_43:
    v_mov_b32 v56, 0
    v_mov_b32 v57, 0
    v_mov_b32 v58, 0xf149f2ca
    v_mov_b32 v59, 0
L_nxt_44:
    s_add_u32 s94, s94, 32768
    s_add_u32 s95, s95, 32768
    s_bitcmp1_b32 s77, 7
    s_cbranch_scc0 L_ina_45
    buffer_load_dword v60, v24, s[48:51], s94 offen sc1
    buffer_load_dword v61, v24, s[48:51], s94 offen offset:64 sc1
    buffer_load_dword v62, v25, s[48:51], s95 offen sc1
    buffer_load_dword v63, v25, s[48:51], s95 offen offset:64 sc1
    s_branch L_nxt_46
L_ina_45:
    v_mov_b32 v60, 0
    v_mov_b32 v61, 0
    v_mov_b32 v62, 0xf149f2ca
    v_mov_b32 v63, 0
L_nxt_46:
L_B_noearly:
    v_mov_b32 v13, v6
    s_nop 1
    v_permlane16_swap_b32 v6, v13
    v_add_f32 v6, v6, v13
    v_mov_b32 v13, v6
    s_nop 1
    v_permlane32_swap_b32 v6, v13
    v_add_f32 v6, v6, v13
    v_mbcnt_lo_u32_b32 v15, -1, 0
    v_mbcnt_hi_u32_b32 v15, -1, v15
    v_and_b32 v8, 15, v15
    v_lshrrev_b32 v9, 4, v15
    v_lshlrev_b32 v10, 2, v8
    s_lshl_b32 s68, s52, 7
    v_add_u32 v11, s68, v10
    ds_write_b32 v11, v5 offset:0
    ds_write_b32 v11, v6 offset:64
    s_waitcnt lgkmcnt(0)
    s_barrier
    ds_read_b32 v16, v10 offset:0
    ds_read_b32 v20, v10 offset:64
    ds_read_b32 v17, v10 offset:128
    ds_read_b32 v21, v10 offset:192
    ds_read_b32 v18, v10 offset:256
    ds_read_b32 v22, v10 offset:320
    ds_read_b32 v19, v10 offset:384
    ds_read_b32 v23, v10 offset:448
    s_waitcnt lgkmcnt(0)
    v_max3_f32 v12, v16, v17, v18
    v_max_f32 v12, v12, v19
    v_sub_f32 v16, v16, v12
    v_sub_f32 v17, v17, v12
    v_sub_f32 v18, v18, v12
    v_sub_f32 v19, v19, v12
    v_sub_f32 v13, v5, v12
    v_exp_f32 v16, v16
    v_exp_f32 v17, v17
    v_exp_f32 v18, v18
    v_exp_f32 v19, v19
    v_exp_f32 v13, v13
    v_mul_f32 v14, v16, v20
    v_fma_f32 v14, v17, v21, v14
    v_fma_f32 v14, v18, v22, v14
    v_fma_f32 v14, v19, v23, v14
    ds_write_b32 v10, v12 offset:512
    ds_write_b32 v10, v14 offset:576
    v_cmp_gt_u32 vcc, 2, v8
    s_and_saveexec_b64 s[78:79], vcc
    v_mul_f32 v64, v13, v64
    v_mul_f32 v65, v13, v65
    v_mul_f32 v66, v13, v66
    v_mul_f32 v67, v13, v67
    v_mul_f32 v68, v13, v68
    v_mul_f32 v69, v13, v69
    v_mul_f32 v70, v13, v70
    v_mul_f32 v71, v13, v71
    v_mul_f32 v72, v13, v72
    v_mul_f32 v73, v13, v73
    v_mul_f32 v74, v13, v74
    v_mul_f32 v75, v13, v75
    v_mul_f32 v76, v13, v76
    v_mul_f32 v77, v13, v77
    v_mul_f32 v78, v13, v78
    v_mul_f32 v79, v13, v79
    v_mul_f32 v80, v13, v80
    v_mul_f32 v81, v13, v81
    v_mul_f32 v82, v13, v82
    v_mul_f32 v83, v13, v83
    v_mul_f32 v84, v13, v84
    v_mul_f32 v85, v13, v85
    v_mul_f32 v86, v13, v86
    v_mul_f32 v87, v13, v87
    v_mul_f32 v88, v13, v88
    v_mul_f32 v89, v13, v89
    v_mul_f32 v90, v13, v90
    v_mul_f32 v91, v13, v91
    v_mul_f32 v92, v13, v92
    v_mul_f32 v93, v13, v93
    v_mul_f32 v94, v13, v94
    v_mul_f32 v95, v13, v95
    v_mul_f32 v96, v13, v96
    v_mul_f32 v97, v13, v97
    v_mul_f32 v98, v13, v98
    v_mul_f32 v99, v13, v99
    v_mul_f32 v100, v13, v100
    v_mul_f32 v101, v13, v101
    v_mul_f32 v102, v13, v102
    v_mul_f32 v103, v13, v103
    v_mul_f32 v104, v13, v104
    v_mul_f32 v105, v13, v105
    v_mul_f32 v106, v13, v106
    v_mul_f32 v107, v13, v107
    v_mul_f32 v108, v13, v108
    v_mul_f32 v109, v13, v109
    v_mul_f32 v110, v13, v110
    v_mul_f32 v111, v13, v111
    v_mul_f32 v112, v13, v112
    v_mul_f32 v113, v13, v113
    v_mul_f32 v114, v13, v114
    v_mul_f32 v115, v13, v115
    v_mul_f32 v116, v13, v116
    v_mul_f32 v117, v13, v117
    v_mul_f32 v118, v13, v118
    v_mul_f32 v119, v13, v119
    v_mul_f32 v120, v13, v120
    v_mul_f32 v121, v13, v121
    v_mul_f32 v122, v13, v122
    v_mul_f32 v123, v13, v123
    v_mul_f32 v124, v13, v124
    v_mul_f32 v125, v13, v125
    v_mul_f32 v126, v13, v126
    v_mul_f32 v127, v13, v127
    s_mul_i32 s68, s52, 16640
    v_mul_u32_u24 v11, 1040, v8
    v_lshl_add_u32 v11, v9, 4, v11
    v_add_u32 v11, s68, v11
    ds_write_b128 v11, v[64:67] offset:1024
    ds_write_b128 v11, v[68:71] offset:1088
    ds_write_b128 v11, v[72:75] offset:1152
    ds_write_b128 v11, v[76:79] offset:1216
    ds_write_b128 v11, v[80:83] offset:1280
    ds_write_b128 v11, v[84:87] offset:1344
    ds_write_b128 v11, v[88:91] offset:1408
    ds_write_b128 v11, v[92:95] offset:1472
    ds_write_b128 v11, v[96:99] offset:1536
    ds_write_b128 v11, v[100:103] offset:1600
    ds_write_b128 v11, v[104:107] offset:1664
    ds_write_b128 v11, v[108:111] offset:1728
    ds_write_b128 v11, v[112:115] offset:1792
    ds_write_b128 v11, v[116:119] offset:1856
    ds_write_b128 v11, v[120:123] offset:1920
    ds_write_b128 v11, v[124:127] offset:1984
    s_mov_b64 exec, s[78:79]
    v_mov_b32 v12, s89
    s_lshl_b32 s68, s52, 2
    v_mov_b32 v13, s68
    ds_write_b32 v13, v12 offset:640
    s_cmp_lg_u32 s52, 0
    s_cbranch_scc1 L_B_nolast
    v_mov_b32 v12, s90
    ds_write_b32 v25, v12 offset:676
L_B_nolast:
    s_waitcnt lgkmcnt(0)
    s_barrier
    s_lshl_b32 s68, s88, 10
    v_add_u32 v11, s68, v24
    s_lshl_b32 s68, s88, 2
    v_mov_b32 v10, s68
    s_mul_i32 s68, s88, 1040
    v_add_u32 v76, s68, v24
    v_add_u32 v72, 1024, v76
    v_add_u32 v73, 17664, v76
    v_add_u32 v74, 34304, v76
    v_add_u32 v75, 50944, v76
    ds_read2_b32 v[64:65], v72 offset0:0 offset1:16
    ds_read2_b32 v[66:67], v73 offset0:0 offset1:16
    ds_read2_b32 v[68:69], v74 offset0:0 offset1:16
    ds_read2_b32 v[70:71], v75 offset0:0 offset1:16
    ds_read_b32 v22, v10 offset:512
    ds_read_b32 v23, v10 offset:576
    ds_read_b128 v[28:31], v25 offset:640
    ds_read_b32 v16, v25 offset:676
    s_waitcnt lgkmcnt(0)
    v_and_b32 v28, v28, v29
    v_and_b32 v30, v30, v31
    v_and_b32 v28, v28, v30
    v_add_f32 v20, v64, v66
    v_readfirstlane_b32 s89, v28
    v_readfirstlane_b32 s90, v16
    v_add_f32 v21, v65, v67
    v_add_f32 v20, v20, v68
    v_add_f32 v21, v21, v69
    v_add_f32 v20, v20, v70
    v_add_f32 v21, v21, v71
    s_cmp_eq_u32 s89, 1
    s_cbranch_scc1 L_B_final
    s_lshl_b32 s68, s54, 3
    s_add_u32 s68, s68, s53
    s_lshl_b32 s68, s68, 12
    s_add_u32 s68, s68, 8388608
    buffer_store_dword v20, v11, s[48:51], s68 offen sc1
    buffer_store_dword v21, v11, s[48:51], s68 offen offset:64 sc1
    buffer_store_dword v22, v10, s[48:51], s68 offen offset:2048 sc1
    buffer_store_dword v23, v10, s[48:51], s68 offen offset:2112 sc1
    s_waitcnt vmcnt(0)
    s_barrier
    s_cmp_lg_u32 s52, 0
    s_cbranch_scc1 L_B_noatom
    s_lshl_b32 s92, s54, 3
    s_add_u32 s92, s92, s53
    s_and_b32 s93, s92, 0xfc
    s_and_b32 s94, s92, 3
    s_lshl_b32 s94, s94, 3
    s_lshl_b32 s68, 1, s94
    v_mov_b32 v28, s68
    v_cmp_eq_u32 vcc, 0, v15
    s_and_saveexec_b64 s[78:79], vcc
    buffer_atomic_add v28, v25, s[44:47], s93 offen sc0 sc1
    s_waitcnt vmcnt(0)
    v_lshrrev_b32 v28, s94, v28
    v_and_b32 v28, 0xff, v28
    ds_write_b32 v25, v28 offset:672
    s_mov_b64 exec, s[78:79]
L_B_noatom:
    s_waitcnt lgkmcnt(0)
    s_barrier
    ds_read_b32 v28, v25 offset:672
    s_waitcnt lgkmcnt(0)
    v_readfirstlane_b32 s68, v28
    s_nop 1
    s_cmp_lg_u32 s68, s86
    s_cbranch_scc1 L_lastloop
    s_and_b32 s92, s91, 7
    s_lshl_b32 s92, s92, 1
    s_add_u32 s92, s92, s88
    s_lshl_b32 s93, s53, 2
    s_add_u32 s93, s93, s101
    s_lshl_b32 s93, s93, 18
    s_lshl_b32 s94, s92, 10
    s_add_u32 s94, s94, s93
    s_lshl_b32 s95, s92, 2
    s_add_u32 s95, s95, s93
    s_add_u32 s95, s95, 0x4000
    s_bitcmp1_b32 s77, 0
    s_cbranch_scc0 L_ina_47
    buffer_load_dword v32, v24, s[48:51], s94 offen sc1
    buffer_load_dword v33, v24, s[48:51], s94 offen offset:64 sc1
    buffer_load_dword v34, v25, s[48:51], s95 offen sc1
    buffer_load_dword v35, v25, s[48:51], s95 offen offset:64 sc1
    s_branch L_nxt_48
L_ina_47:
    v_mov_b32 v32, 0
    v_mov_b32 v33, 0
    v_mov_b32 v34, 0xf149f2ca
    v_mov_b32 v35, 0
L_nxt_48:
    s_add_u32 s94, s94, 32768
    s_add_u32 s95, s95, 32768
    s_bitcmp1_b32 s77, 1
    s_cbranch_scc0 L_ina_49
    buffer_load_dword v36, v24, s[48:51], s94 offen sc1
    buffer_load_dword v37, v24, s[48:51], s94 offen offset:64 sc1
    buffer_load_dword v38, v25, s[48:51], s95 offen sc1
    buffer_load_dword v39, v25, s[48:51], s95 offen offset:64 sc1
    s_branch L_nxt_50
L_ina_49:
    v_mov_b32 v36, 0
    v_mov_b32 v37, 0
    v_mov_b32 v38, 0xf149f2ca
    v_mov_b32 v39, 0
L_nxt_50:
    s_add_u32 s94, s94, 32768
    s_add_u32 s95, s95, 32768
    s_bitcmp1_b32 s77, 2
    s_cbranch_scc0 L_ina_51
    buffer_load_dword v40, v24, s[48:51], s94 offen sc1
    buffer_load_dword v41, v24, s[48:51], s94 offen offset:64 sc1
    buffer_load_dword v42, v25, s[48:51], s95 offen sc1
    buffer_load_dword v43, v25, s[48:51], s95 offen offset:64 sc1
    s_branch L_nxt_52
L_ina_51:
    v_mov_b32 v40, 0
    v_mov_b32 v41, 0
    v_mov_b32 v42, 0xf149f2ca
    v_mov_b32 v43, 0
L_nxt_52:
    s_add_u32 s94, s94, 32768
    s_add_u32 s95, s95, 32768
    s_bitcmp1_b32 s77, 3
    s_cbranch_scc0 L_ina_53
    buffer_load_dword v44, v24, s[48:51], s94 offen sc1
    buffer_load_dword v45, v24, s[48:51], s94 offen offset:64 sc1
    buffer_load_dword v46, v25, s[48:51], s95 offen sc1
    buffer_load_dword v47, v25, s[48:51], s95 offen offset:64 sc1
    s_branch L_nxt_54
L_ina_53:
    v_mov_b32 v44, 0
    v_mov_b32 v45, 0
    v_mov_b32 v46, 0xf149f2ca
    v_mov_b32 v47, 0
L_nxt_54:
    s_add_u32 s94, s94, 32768
    s_add_u32 s95, s95, 32768
    s_bitcmp1_b32 s77, 4
    s_cbranch_scc0 L_ina_55
    buffer_load_dword v48, v24, s[48:51], s94 offen sc1
    buffer_load_dword v49, v24, s[48:51], s94 offen offset:64 sc1
    buffer_load_dword v50, v25, s[48:51], s95 offen sc1
    buffer_load_dword v51, v25, s[48:51], s95 offen offset:64 sc1
    s_branch L_nxt_56
L_ina_55:
    v_mov_b32 v48, 0
    v_mov_b32 v49, 0
    v_mov_b32 v50, 0xf149f2ca
    v_mov_b32 v51, 0
L_nxt_56:
    s_add_u32 s94, s94, 32768
    s_add_u32 s95, s95, 32768
    s_bitcmp1_b32 s77, 5
    s_cbranch_scc0 L_ina_57
    buffer_load_dword v52, v24, s[48:51], s94 offen sc1
    buffer_load_dword v53, v24, s[48:51], s94 offen offset:64 sc1
    buffer_load_dword v54, v25, s[48:51], s95 offen sc1
    buffer_load_dword v55, v25, s[48:51], s95 offen offset:64 sc1
    s_branch L_nxt_58
L_ina_57:
    v_mov_b32 v52, 0
    v_mov_b32 v53, 0
    v_mov_b32 v54, 0xf149f2ca
    v_mov_b32 v55, 0
L_nxt_58:
    s_add_u32 s94, s94, 32768
    s_add_u32 s95, s95, 32768
    s_bitcmp1_b32 s77, 6
    s_cbranch_scc0 L_ina_59
    buffer_load_dword v56, v24, s[48:51], s94 offen sc1
    buffer_load_dword v57, v24, s[48:51], s94 offen offset:64 sc1
    buffer_load_dword v58, v25, s[48:51], s95 offen sc1
    buffer_load_dword v59, v25, s[48:51], s95 offen offset:64 sc1
    s_branch L_nxt_60
L_ina_59:
    v_mov_b32 v56, 0
    v_mov_b32 v57, 0
    v_mov_b32 v58, 0xf149f2ca
    v_mov_b32 v59, 0
L_nxt_60:
    s_add_u32 s94, s94, 32768
    s_add_u32 s95, s95, 32768
    s_bitcmp1_b32 s77, 7
    s_cbranch_scc0 L_ina_61
    buffer_load_dword v60, v24, s[48:51], s94 offen sc1
    buffer_load_dword v61, v24, s[48:51], s94 offen offset:64 sc1
    buffer_load_dword v62, v25, s[48:51], s95 offen sc1
    buffer_load_dword v63, v25, s[48:51], s95 offen offset:64 sc1
    s_branch L_nxt_62
L_ina_61:
    v_mov_b32 v60, 0
    v_mov_b32 v61, 0
    v_mov_b32 v62, 0xf149f2ca
    v_mov_b32 v63, 0
L_nxt_62:
L_B_final:
    s_waitcnt vmcnt(0)
    v_max3_f32 v27, v22, v34, v38
    v_max3_f32 v27, v27, v42, v46
    v_max3_f32 v27, v27, v50, v54
    v_max3_f32 v27, v27, v58, v62
    v_sub_f32 v22, v22, v27
    v_sub_f32 v34, v34, v27
    v_sub_f32 v38, v38, v27
    v_sub_f32 v42, v42, v27
    v_sub_f32 v46, v46, v27
    v_sub_f32 v50, v50, v27
    v_sub_f32 v54, v54, v27
    v_sub_f32 v58, v58, v27
    v_sub_f32 v62, v62, v27
    v_exp_f32 v22, v22
    v_exp_f32 v34, v34
    v_exp_f32 v38, v38
    v_exp_f32 v42, v42
    v_exp_f32 v46, v46
    v_exp_f32 v50, v50
    v_exp_f32 v54, v54
    v_exp_f32 v58, v58
    v_exp_f32 v62, v62
    s_nop 0
    v_mul_f32 v20, v20, v22
    v_mul_f32 v21, v21, v22
    v_mul_f32 v23, v23, v22
    v_fma_f32 v20, v32, v34, v20
    v_fma_f32 v21, v33, v34, v21
    v_fma_f32 v23, v35, v34, v23
    v_fma_f32 v20, v36, v38, v20
    v_fma_f32 v21, v37, v38, v21
    v_fma_f32 v23, v39, v38, v23
    v_fma_f32 v20, v40, v42, v20
    v_fma_f32 v21, v41, v42, v21
    v_fma_f32 v23, v43, v42, v23
    v_fma_f32 v20, v44, v46, v20
    v_fma_f32 v21, v45, v46, v21
    v_fma_f32 v23, v47, v46, v23
    v_fma_f32 v20, v48, v50, v20
    v_fma_f32 v21, v49, v50, v21
    v_fma_f32 v23, v51, v50, v23
    v_fma_f32 v20, v52, v54, v20
    v_fma_f32 v21, v53, v54, v21
    v_fma_f32 v23, v55, v54, v23
    v_fma_f32 v20, v56, v58, v20
    v_fma_f32 v21, v57, v58, v21
    v_fma_f32 v23, v59, v58, v23
    v_fma_f32 v20, v60, v62, v20
    v_fma_f32 v21, v61, v62, v21
    v_fma_f32 v23, v63, v62, v23
    v_rcp_f32 v23, v23
    s_nop 0
    v_mul_f32 v20, v20, v23
    v_mul_f32 v21, v21, v23
    v_cvt_pk_bf16_f32 v20, v20, v21
    s_lshl_b32 s92, s91, 4
    s_lshl_b32 s93, s53, 1
    s_add_u32 s92, s92, s93
    s_add_u32 s92, s92, s88
    s_lshl_b32 s92, s92, 9
    buffer_store_dword v20, v26, s[40:43], s92 offen
L_lastloop:
    s_cmp_eq_u32 s90, 0
    s_cbranch_scc1 L_end
    s_ff1_i32_b32 s68, s90
    s_bitset0_b32 s90, s68
    s_lshl_b32 s91, s57, 3
    s_add_u32 s91, s91, s68
    s_mov_b32 s101, s57
    s_lshl_b32 s68, s91, 3
    s_add_u32 s68, s68, s53
    s_lshl_b32 s68, s68, 12
    s_add_u32 s68, s68, 8388608
    s_lshl_b32 s69, s88, 10
    v_add_u32 v11, s69, v24
    s_lshl_b32 s69, s88, 2
    v_mov_b32 v10, s69
    s_waitcnt vmcnt(0)
    buffer_load_dword v20, v11, s[48:51], s68 offen sc1
    buffer_load_dword v21, v11, s[48:51], s68 offen offset:64 sc1
    buffer_load_dword v22, v10, s[48:51], s68 offen offset:2048 sc1
    buffer_load_dword v23, v10, s[48:51], s68 offen offset:2112 sc1
    s_and_b32 s92, s91, 7
    s_lshl_b32 s92, s92, 1
    s_add_u32 s92, s92, s88
    s_lshl_b32 s93, s53, 2
    s_add_u32 s93, s93, s101
    s_lshl_b32 s93, s93, 18
    s_lshl_b32 s94, s92, 10
    s_add_u32 s94, s94, s93
    s_lshl_b32 s95, s92, 2
    s_add_u32 s95, s95, s93
    s_add_u32 s95, s95, 0x4000
    s_bitcmp1_b32 s99, 0
    s_cbranch_scc0 L_ina_63
    buffer_load_dword v32, v24, s[48:51], s94 offen sc1
    buffer_load_dword v33, v24, s[48:51], s94 offen offset:64 sc1
    buffer_load_dword v34, v25, s[48:51], s95 offen sc1
    buffer_load_dword v35, v25, s[48:51], s95 offen offset:64 sc1
    s_branch L_nxt_64
L_ina_63:
    v_mov_b32 v32, 0
    v_mov_b32 v33, 0
    v_mov_b32 v34, 0xf149f2ca
    v_mov_b32 v35, 0
L_nxt_64:
    s_add_u32 s94, s94, 32768
    s_add_u32 s95, s95, 32768
    s_bitcmp1_b32 s99, 1
    s_cbranch_scc0 L_ina_65
    buffer_load_dword v36, v24, s[48:51], s94 offen sc1
    buffer_load_dword v37, v24, s[48:51], s94 offen offset:64 sc1
    buffer_load_dword v38, v25, s[48:51], s95 offen sc1
    buffer_load_dword v39, v25, s[48:51], s95 offen offset:64 sc1
    s_branch L_nxt_66
L_ina_65:
    v_mov_b32 v36, 0
    v_mov_b32 v37, 0
    v_mov_b32 v38, 0xf149f2ca
    v_mov_b32 v39, 0
L_nxt_66:
    s_add_u32 s94, s94, 32768
    s_add_u32 s95, s95, 32768
    s_bitcmp1_b32 s99, 2
    s_cbranch_scc0 L_ina_67
    buffer_load_dword v40, v24, s[48:51], s94 offen sc1
    buffer_load_dword v41, v24, s[48:51], s94 offen offset:64 sc1
    buffer_load_dword v42, v25, s[48:51], s95 offen sc1
    buffer_load_dword v43, v25, s[48:51], s95 offen offset:64 sc1
    s_branch L_nxt_68
L_ina_67:
    v_mov_b32 v40, 0
    v_mov_b32 v41, 0
    v_mov_b32 v42, 0xf149f2ca
    v_mov_b32 v43, 0
L_nxt_68:
    s_add_u32 s94, s94, 32768
    s_add_u32 s95, s95, 32768
    s_bitcmp1_b32 s99, 3
    s_cbranch_scc0 L_ina_69
    buffer_load_dword v44, v24, s[48:51], s94 offen sc1
    buffer_load_dword v45, v24, s[48:51], s94 offen offset:64 sc1
    buffer_load_dword v46, v25, s[48:51], s95 offen sc1
    buffer_load_dword v47, v25, s[48:51], s95 offen offset:64 sc1
    s_branch L_nxt_70
L_ina_69:
    v_mov_b32 v44, 0
    v_mov_b32 v45, 0
    v_mov_b32 v46, 0xf149f2ca
    v_mov_b32 v47, 0
L_nxt_70:
    s_add_u32 s94, s94, 32768
    s_add_u32 s95, s95, 32768
    s_bitcmp1_b32 s99, 4
    s_cbranch_scc0 L_ina_71
    buffer_load_dword v48, v24, s[48:51], s94 offen sc1
    buffer_load_dword v49, v24, s[48:51], s94 offen offset:64 sc1
    buffer_load_dword v50, v25, s[48:51], s95 offen sc1
    buffer_load_dword v51, v25, s[48:51], s95 offen offset:64 sc1
    s_branch L_nxt_72
L_ina_71:
    v_mov_b32 v48, 0
    v_mov_b32 v49, 0
    v_mov_b32 v50, 0xf149f2ca
    v_mov_b32 v51, 0
L_nxt_72:
    s_add_u32 s94, s94, 32768
    s_add_u32 s95, s95, 32768
    s_bitcmp1_b32 s99, 5
    s_cbranch_scc0 L_ina_73
    buffer_load_dword v52, v24, s[48:51], s94 offen sc1
    buffer_load_dword v53, v24, s[48:51], s94 offen offset:64 sc1
    buffer_load_dword v54, v25, s[48:51], s95 offen sc1
    buffer_load_dword v55, v25, s[48:51], s95 offen offset:64 sc1
    s_branch L_nxt_74
L_ina_73:
    v_mov_b32 v52, 0
    v_mov_b32 v53, 0
    v_mov_b32 v54, 0xf149f2ca
    v_mov_b32 v55, 0
L_nxt_74:
    s_add_u32 s94, s94, 32768
    s_add_u32 s95, s95, 32768
    s_bitcmp1_b32 s99, 6
    s_cbranch_scc0 L_ina_75
    buffer_load_dword v56, v24, s[48:51], s94 offen sc1
    buffer_load_dword v57, v24, s[48:51], s94 offen offset:64 sc1
    buffer_load_dword v58, v25, s[48:51], s95 offen sc1
    buffer_load_dword v59, v25, s[48:51], s95 offen offset:64 sc1
    s_branch L_nxt_76
L_ina_75:
    v_mov_b32 v56, 0
    v_mov_b32 v57, 0
    v_mov_b32 v58, 0xf149f2ca
    v_mov_b32 v59, 0
L_nxt_76:
    s_add_u32 s94, s94, 32768
    s_add_u32 s95, s95, 32768
    s_bitcmp1_b32 s99, 7
    s_cbranch_scc0 L_ina_77
    buffer_load_dword v60, v24, s[48:51], s94 offen sc1
    buffer_load_dword v61, v24, s[48:51], s94 offen offset:64 sc1
    buffer_load_dword v62, v25, s[48:51], s95 offen sc1
    buffer_load_dword v63, v25, s[48:51], s95 offen offset:64 sc1
    s_branch L_nxt_78
L_ina_77:
    v_mov_b32 v60, 0
    v_mov_b32 v61, 0
    v_mov_b32 v62, 0xf149f2ca
    v_mov_b32 v63, 0
L_nxt_78:
    s_waitcnt vmcnt(0)
    v_max3_f32 v27, v22, v34, v38
    v_max3_f32 v27, v27, v42, v46
    v_max3_f32 v27, v27, v50, v54
    v_max3_f32 v27, v27, v58, v62
    v_sub_f32 v22, v22, v27
    v_sub_f32 v34, v34, v27
    v_sub_f32 v38, v38, v27
    v_sub_f32 v42, v42, v27
    v_sub_f32 v46, v46, v27
    v_sub_f32 v50, v50, v27
    v_sub_f32 v54, v54, v27
    v_sub_f32 v58, v58, v27
    v_sub_f32 v62, v62, v27
    v_exp_f32 v22, v22
    v_exp_f32 v34, v34
    v_exp_f32 v38, v38
    v_exp_f32 v42, v42
    v_exp_f32 v46, v46
    v_exp_f32 v50, v50
    v_exp_f32 v54, v54
    v_exp_f32 v58, v58
    v_exp_f32 v62, v62
    s_nop 0
    v_mul_f32 v20, v20, v22
    v_mul_f32 v21, v21, v22
    v_mul_f32 v23, v23, v22
    v_fma_f32 v20, v32, v34, v20
    v_fma_f32 v21, v33, v34, v21
    v_fma_f32 v23, v35, v34, v23
    v_fma_f32 v20, v36, v38, v20
    v_fma_f32 v21, v37, v38, v21
    v_fma_f32 v23, v39, v38, v23
    v_fma_f32 v20, v40, v42, v20
    v_fma_f32 v21, v41, v42, v21
    v_fma_f32 v23, v43, v42, v23
    v_fma_f32 v20, v44, v46, v20
    v_fma_f32 v21, v45, v46, v21
    v_fma_f32 v23, v47, v46, v23
    v_fma_f32 v20, v48, v50, v20
    v_fma_f32 v21, v49, v50, v21
    v_fma_f32 v23, v51, v50, v23
    v_fma_f32 v20, v52, v54, v20
    v_fma_f32 v21, v53, v54, v21
    v_fma_f32 v23, v55, v54, v23
    v_fma_f32 v20, v56, v58, v20
    v_fma_f32 v21, v57, v58, v21
    v_fma_f32 v23, v59, v58, v23
    v_fma_f32 v20, v60, v62, v20
    v_fma_f32 v21, v61, v62, v21
    v_fma_f32 v23, v63, v62, v23
    v_rcp_f32 v23, v23
    s_nop 0
    v_mul_f32 v20, v20, v23
    v_mul_f32 v21, v21, v23
    v_cvt_pk_bf16_f32 v20, v20, v21
    s_lshl_b32 s92, s91, 4
    s_lshl_b32 s93, s53, 1
    s_add_u32 s92, s92, s93
    s_add_u32 s92, s92, s88
    s_lshl_b32 s92, s92, 9
    buffer_store_dword v20, v26, s[40:43], s92 offen
    s_branch L_lastloop
L_end:
    s_endpgm
.section .rodata,"a"
.p2align 6
.amdhsa_kernel standalone__paged_block_table_kv_radixattention__sampling_kernel
  .amdhsa_next_free_vgpr 256
  .amdhsa_next_free_sgpr 102
  .amdhsa_accum_offset 256
  .amdhsa_group_segment_fixed_size 0
  .amdhsa_kernarg_size 64
  .amdhsa_user_sgpr_count 2
  .amdhsa_user_sgpr_kernarg_segment_ptr 1
  .amdhsa_system_sgpr_workgroup_id_x 1
.end_amdhsa_kernel
```
